```python
import torch

def _softmax(x, axis=-1):
    return torch.softmax(x, dim=axis)
def _gelu(x):
    return torch.nn.functional.gelu(x, approximate="tanh")
def _silu(x):
    return torch.nn.functional.silu(x)
def _sigmoid(x):
    return torch.sigmoid(x)
def _layernorm(x, axis=-1, eps=1e-5):
    m = x.mean(dim=axis, keepdim=True)
    v = x.var(dim=axis, keepdim=True, unbiased=False)
    return (x - m) / torch.sqrt(v + eps)
def _scatter_add(tgt, idx, src, axis=0):
    return tgt.clone().index_add_(axis, idx, src)
def _segment_sum(src, seg, n):
    out = torch.zeros((n,) + src.shape[1:], dtype=src.dtype)
    return out.index_add_(0, seg, src)
def _pad(x, pw):
    flat = tuple(v for pair in reversed(pw) for v in pair)
    return torch.nn.functional.pad(x, flat)

kernel_name = 'concat_heads__ssm_conv_s4__linear_attn_block__prompt'

def setup_inputs():

    _w = (lambda a: (lambda t: t.to(torch.bfloat16) if t.is_floating_point() else t)(torch.as_tensor(a)))
    def _A_setup():
        B, L, D, N = 1, 2048, 448, 256
        A_re = -(lambda _x: torch.exp(torch.as_tensor(_x)))((lambda *s: torch.randn(*s, dtype=torch.bfloat16) * 3.2)(D, N))
        A_im = torch.pi * (lambda *s: torch.randn(*s, dtype=torch.bfloat16) * 0.05)(D, N)
        B_re = (lambda *s: torch.randn(*s, dtype=torch.bfloat16) * 0.2)(D, N)
        B_im = (lambda *s: torch.randn(*s, dtype=torch.bfloat16) * 0.2)(D, N)
        C_re = (lambda *s: torch.randn(*s, dtype=torch.bfloat16) * 0.2)(D, N)
        C_im = (lambda *s: torch.randn(*s, dtype=torch.bfloat16) * 0.2)(D, N)
        log_dt = (lambda *s: torch.randn(*s, dtype=torch.bfloat16) * 0.05)(D) * 0.5 - 4.0
        Dskip = (lambda *s: torch.randn(*s, dtype=torch.bfloat16) * 0.05)(D)
        return {
            "u": _w((lambda *s: torch.randn(*s, dtype=torch.bfloat16) * 0.05)(B, L, D)),
            "A_re": _w(A_re),
            "A_im": _w(A_im),
            "B_re": _w(B_re),
            "B_im": _w(B_im),
            "C_re": _w(C_re),
            "C_im": _w(C_im),
            "log_dt": _w(log_dt),
            "Dskip": _w(Dskip),
        }
    _A_in = _A_setup()

    def _B_setup():
        B, S, D = 1, 2048, 448
        return {
            "x": _w((lambda *s: torch.randn(*s, dtype=torch.bfloat16) * 0.05)(B, S, D)),
            "wqkv": _w((lambda *s: torch.randn(*s, dtype=torch.bfloat16) * 0.8)(D, 3 * D)),
            "wo": _w((lambda *s: torch.randn(*s, dtype=torch.bfloat16) * 0.1)(D, D)),
        }
    _B_in = _B_setup()

    return {
        "A_u": _A_in["u"],
        "A_A_re": _A_in["A_re"],
        "A_A_im": _A_in["A_im"],
        "A_B_re": _A_in["B_re"],
        "A_B_im": _A_in["B_im"],
        "A_C_re": _A_in["C_re"],
        "A_C_im": _A_in["C_im"],
        "A_log_dt": _A_in["log_dt"],
        "A_Dskip": _A_in["Dskip"],
        "B_x": _B_in["x"],
        "B_wqkv": _B_in["wqkv"],
        "B_wo": _B_in["wo"],
    }

def reference(A_u, A_A_re, A_A_im, A_B_re, A_B_im, A_C_re, A_C_im, A_log_dt, A_Dskip, B_x, B_wqkv, B_wo):
    def _A_ref(u, A_re, A_im, B_re, B_im, C_re, C_im, log_dt, Dskip):
        Bsz, L, D = u.shape
        dt = torch.exp(log_dt)[:, None]
        A = A_re + 1j * A_im
        Bc = B_re + 1j * B_im
        Cc = C_re + 1j * C_im
        logdA = dt * A
        dB = dt * Bc
        l = (lambda x, dt: x.to(dt))(torch.arange(L), A_re.dtype)
        P = torch.exp(logdA[:, :, None] * l[None, None, :])
        K = torch.einsum("dn,dnl,dn->dl", Cc, P, dB).real
        L2 = 2 * L
        Kp = _pad(K, ((0, 0), (0, L)))
        up = (lambda x, *d: x.permute(*d))(u, 0, 2, 1)
        up = _pad(up, ((0, 0), (0, 0), (0, L)))
        Kf = (lambda x, axes=(-2,-1): torch.fft.rfft2(x.float(), dim=axes))(Kp[:, None, :], axes=(-2, -1))
        Uf = (lambda x, axes=(-2,-1): torch.fft.rfft2(x.float(), dim=axes))(up[:, :, None, :], axes=(-2, -1))
        Yf = Uf * Kf[None, :, :, :]
        y = (lambda x, s, axes=(-2,-1): torch.fft.irfft2(x, s=s, dim=axes).to(torch.bfloat16))(Yf, (1, L2), axes=(-2, -1))[:, :, 0, :L]
        y = (lambda x, *d: x.permute(*d))(y, 0, 2, 1) + u * Dskip[None, None, :]
        return y

    def _B_ref(x, wqkv, wo):
        B, S, D = x.shape
        H = 16; Dh = D // H
        qkv = (lambda x, *d: x.permute(*d))((x @ wqkv).reshape(B, S, 3, H, Dh), 2, 0, 3, 1, 4)
        q, k, v = qkv[0], qkv[1], qkv[2]
        phi = lambda t: torch.where(t > 0, t + 1, torch.exp(t)) + 1e-6
        pq, pk = phi(q), phi(k)
        kv = torch.einsum("bhsd,bhse->bhde", pk, v)
        z = torch.einsum("bhsd->bhd", pk)
        num = torch.einsum("bhqd,bhde->bhqe", pq, kv)
        den = torch.einsum("bhqd,bhd->bhq", pq, z)[..., None] + 1e-6
        o = num / den
        return (lambda x, *d: x.permute(*d))(o, 0, 2, 1, 3).reshape(B, S, D) @ wo

    a = _A_ref(A_u, A_A_re, A_A_im, A_B_re, A_B_im, A_C_re, A_C_im, A_log_dt, A_Dskip)
    b = _B_ref(B_x, B_wqkv, B_wo)
    return torch.concatenate([a, b], axis=-1)
```

```asm
; @launch grid=(256,1,1) block=(512,1,1) lds=163840
.amdgcn_target "amdgcn-amd-amdhsa--gfx950"
.text
.globl concat_heads__ssm_conv_s4__linear_attn_block__prompt_kernel
.p2align 8
.type concat_heads__ssm_conv_s4__linear_attn_block__prompt_kernel,@function
concat_heads__ssm_conv_s4__linear_attn_block__prompt_kernel:
  s_cmp_ge_u32 s2, 256
  s_cbranch_scc1 L_end_concat_heads__ssm_conv_s4__linear_attn_block__prompt_kernel
  s_memrealtime s[98:99]
  s_load_dwordx16 s[16:31], s[0:1], 0
  s_load_dwordx8 s[32:39], s[0:1], 64
  s_load_dwordx4 s[40:43], s[0:1], 96
  s_load_dwordx2 s[44:45], s[0:1], 112
  v_lshrrev_b32 v2, 6, v0
  v_and_b32 v1, 63, v0
  v_readfirstlane_b32 s3, v2
  s_cmp_ge_u32 s2, 128
  s_cbranch_scc1 L_roleA_concat_heads__ssm_conv_s4__linear_attn_block__prompt_kernel
  s_and_b32 s4, s2, 7
  s_lshl_b32 s4, s4, 1
  s_bfe_u32 s8, s2, 0x10003
  s_or_b32 s4, s4, s8
  s_lshr_b32 s5, s2, 4
  s_and_b32 s6, s3, 3
  s_lshr_b32 s7, s3, 2
  v_and_b32 v2, 31, v1
  v_lshrrev_b32 v3, 5, v1
  v_bfe_u32 v4, v1, 2, 2
  v_bfe_u32 v6, v1, 4, 1
  v_and_b32 v7, 3, v1
  v_lshlrev_b32 v7, 3, v7
  v_lshl_add_u32 v7, v6, 5, v7
  v_lshrrev_b32 v6, 1, v4
  v_lshlrev_b32 v6, 6, v6
  v_mov_b32 v30, 0
  s_cmp_ge_u32 s3, 4
  s_cbranch_scc1 Lldr_1
  s_or_b32 s8, s2, s3
  s_cmp_lg_u32 s8, 0
  s_cbranch_scc1 Lnonce_3
  s_waitcnt lgkmcnt(0)
  s_or_b32 s8, s98, 1
  v_mov_b32 v8, s8
  s_mov_b64 exec, 1
  global_store_dword v30, v8, s[42:43] sc0 sc1
  s_mov_b64 exec, -1
Lnonce_3:
  s_and_b32 s10, s3, 1
  s_lshr_b32 s11, s3, 1
  v_lshl_add_u32 v5, v3, 3, v4
  v_bfe_u32 v8, v2, 1, 3
  v_xor_b32 v8, v8, v3
  s_lshl_b32 s8, s10, 13
  v_lshl_add_u32 v9, v2, 7, s8
  v_xor_b32 v10, 0, v8
  v_lshl_add_u32 v24, v10, 4, v9
  v_xor_b32 v10, 2, v8
  v_lshl_add_u32 v25, v10, 4, v9
  v_xor_b32 v10, 4, v8
  v_lshl_add_u32 v26, v10, 4, v9
  v_xor_b32 v10, 6, v8
  v_lshl_add_u32 v27, v10, 4, v9
  s_mul_i32 s8, s11, 56
  v_add_u32 v8, s8, v7
  v_xor_b32 v8, v8, v6
  v_lshl_add_u32 v28, v5, 7, v8
  v_mov_b32 v32, 0
  v_mov_b32 v33, 0
  v_mov_b32 v34, 0
  v_mov_b32 v35, 0
  v_mov_b32 v36, 0
  v_mov_b32 v37, 0
  v_mov_b32 v38, 0
  v_mov_b32 v39, 0
  v_mov_b32 v40, 0
  v_mov_b32 v41, 0
  v_mov_b32 v42, 0
  v_mov_b32 v43, 0
  v_mov_b32 v44, 0
  v_mov_b32 v45, 0
  v_mov_b32 v46, 0
  v_mov_b32 v47, 0
  v_mov_b32 v48, 0
  v_mov_b32 v49, 0
  v_mov_b32 v50, 0
  v_mov_b32 v51, 0
  v_mov_b32 v52, 0
  v_mov_b32 v53, 0
  v_mov_b32 v54, 0
  v_mov_b32 v55, 0
  v_mov_b32 v56, 0
  v_mov_b32 v57, 0
  v_mov_b32 v58, 0
  v_mov_b32 v59, 0
  v_mov_b32 v60, 0
  v_mov_b32 v61, 0
  v_mov_b32 v62, 0
  v_mov_b32 v63, 0
  v_mov_b32 v64, 0
  v_mov_b32 v65, 0
  v_mov_b32 v66, 0
  v_mov_b32 v67, 0
  v_mov_b32 v68, 0
  v_mov_b32 v69, 0
  v_mov_b32 v70, 0
  v_mov_b32 v71, 0
  v_mov_b32 v72, 0
  v_mov_b32 v73, 0
  v_mov_b32 v74, 0
  v_mov_b32 v75, 0
  v_mov_b32 v76, 0
  v_mov_b32 v77, 0
  v_mov_b32 v78, 0
  v_mov_b32 v79, 0
  v_mov_b32 v80, 0
  v_mov_b32 v81, 0
  v_mov_b32 v82, 0
  v_mov_b32 v83, 0
  v_mov_b32 v84, 0
  v_mov_b32 v85, 0
  v_mov_b32 v86, 0
  v_mov_b32 v87, 0
  v_mov_b32 v88, 0
  v_mov_b32 v89, 0
  v_mov_b32 v90, 0
  v_mov_b32 v91, 0
  v_mov_b32 v92, 0
  v_mov_b32 v93, 0
  v_mov_b32 v94, 0
  v_mov_b32 v95, 0
  v_mov_b32 v96, 0
  v_mov_b32 v97, 0
  v_mov_b32 v98, 0
  v_mov_b32 v99, 0
  v_mov_b32 v100, 0
  v_mov_b32 v101, 0
  v_mov_b32 v102, 0
  v_mov_b32 v103, 0
  v_mov_b32 v104, 0
  v_mov_b32 v105, 0
  v_mov_b32 v106, 0
  v_mov_b32 v107, 0
  v_mov_b32 v108, 0
  v_mov_b32 v109, 0
  v_mov_b32 v110, 0
  v_mov_b32 v111, 0
  v_mov_b32 v112, 0
  v_mov_b32 v113, 0
  v_mov_b32 v114, 0
  v_mov_b32 v115, 0
  v_mov_b32 v116, 0
  v_mov_b32 v117, 0
  v_mov_b32 v118, 0
  v_mov_b32 v119, 0
  v_mov_b32 v120, 0
  v_mov_b32 v121, 0
  v_mov_b32 v122, 0
  v_mov_b32 v123, 0
  v_mov_b32 v124, 0
  v_mov_b32 v125, 0
  v_mov_b32 v126, 0
  v_mov_b32 v127, 0
  v_mov_b32 v184, 0x3f803f80
  v_mov_b32 v185, 0x3f803f80
  v_mov_b32 v186, 0x3f803f80
  v_mov_b32 v187, 0x3f803f80
  v_mov_b32 v188, 0x3f803f80
  v_mov_b32 v189, 0x3f803f80
  v_mov_b32 v190, 0x3f803f80
  v_mov_b32 v191, 0x3f803f80
  v_mov_b32 v192, 0x3f803f80
  v_mov_b32 v193, 0x3f803f80
  v_mov_b32 v194, 0x3f803f80
  v_mov_b32 v195, 0x3f803f80
  v_mov_b32 v196, 0x3f803f80
  v_mov_b32 v197, 0x3f803f80
  v_mov_b32 v198, 0x3f803f80
  v_mov_b32 v199, 0x3f803f80
  s_mov_b32 s46, 1069066811
  s_mov_b32 s47, 1069066811
  s_mov_b32 s68, 1.0
  s_mov_b32 s69, 1.0
  s_mov_b32 s72, 897988541
  s_mov_b32 s73, 897988541
  s_waitcnt lgkmcnt(0)
  s_mov_b32 s56, s44
  s_mov_b32 s57, s45
  s_mov_b32 s58, 16777216
  s_mov_b32 s59, 0x00020000
  s_mov_b32 s64, s40
  s_mov_b32 s65, s41
  s_mov_b32 s66, 3670016
  s_mov_b32 s67, 0x00020000
  s_lshl_b32 s8, s3, 12
  s_add_u32 s9, s8, 40960
  v_lshl_add_u32 v9, v1, 4, s9
  s_mov_b32 s9, 147456
  s_cmp_lt_u32 s3, 2
  s_cselect_b32 s9, 32768, s9
  s_add_u32 s8, s8, s9
  v_lshl_add_u32 v8, v1, 4, s8
  v_mov_b32 v18, 35840
  s_barrier
  s_barrier
  ds_read_b128 v[128:131], v24
  ds_read_b64_tr_b16 v[136:137], v28 offset:16384
  ds_read_b64_tr_b16 v[138:139], v28 offset:16896
  ds_read_b128 v[132:135], v24 offset:4096
  ds_read_b64_tr_b16 v[140:141], v28 offset:24576
  ds_read_b64_tr_b16 v[142:143], v28 offset:25088
  ds_read_b64_tr_b16 v[144:145], v28 offset:32768
  ds_read_b64_tr_b16 v[146:147], v28 offset:33280
  s_waitcnt lgkmcnt(5)
  v_mfma_f32_32x32x16_bf16 v[32:47], v[128:131], v[136:139], v[32:47]
  ds_read_b128 v[148:151], v25
  ds_read_b64_tr_b16 v[156:157], v28 offset:18432
  ds_read_b64_tr_b16 v[158:159], v28 offset:18944
  s_waitcnt lgkmcnt(7)
  v_mfma_f32_32x32x16_bf16 v[48:63], v[132:135], v[136:139], v[48:63]
  ds_read_b128 v[152:155], v25 offset:4096
  s_waitcnt lgkmcnt(6)
  v_mfma_f32_32x32x16_bf16 v[64:79], v[128:131], v[140:143], v[64:79]
  ds_read_b64_tr_b16 v[160:161], v28 offset:26624
  ds_read_b64_tr_b16 v[162:163], v28 offset:27136
  v_mfma_f32_32x32x16_bf16 v[80:95], v[132:135], v[140:143], v[80:95]
  ds_read_b64_tr_b16 v[164:165], v28 offset:34816
  ds_read_b64_tr_b16 v[166:167], v28 offset:35328
  s_waitcnt lgkmcnt(8)
  v_mfma_f32_32x32x16_bf16 v[96:111], v[144:147], v[128:131], v[96:111]
  v_mfma_f32_32x32x16_bf16 v[112:127], v[144:147], v[132:135], v[112:127]
  s_waitcnt lgkmcnt(5)
  v_mfma_f32_32x32x16_bf16 v[32:47], v[148:151], v[156:159], v[32:47]
  ds_read_b128 v[128:131], v26
  ds_read_b64_tr_b16 v[136:137], v28 offset:20480
  ds_read_b64_tr_b16 v[138:139], v28 offset:20992
  s_waitcnt lgkmcnt(7)
  v_mfma_f32_32x32x16_bf16 v[48:63], v[152:155], v[156:159], v[48:63]
  ds_read_b128 v[132:135], v26 offset:4096
  s_waitcnt lgkmcnt(6)
  v_mfma_f32_32x32x16_bf16 v[64:79], v[148:151], v[160:163], v[64:79]
  ds_read_b64_tr_b16 v[140:141], v28 offset:28672
  ds_read_b64_tr_b16 v[142:143], v28 offset:29184
  v_mfma_f32_32x32x16_bf16 v[80:95], v[152:155], v[160:163], v[80:95]
  ds_read_b64_tr_b16 v[144:145], v28 offset:36864
  ds_read_b64_tr_b16 v[146:147], v28 offset:37376
  s_waitcnt lgkmcnt(8)
  v_mfma_f32_32x32x16_bf16 v[96:111], v[164:167], v[148:151], v[96:111]
  v_mfma_f32_32x32x16_bf16 v[112:127], v[164:167], v[152:155], v[112:127]
  s_waitcnt lgkmcnt(5)
  v_mfma_f32_32x32x16_bf16 v[32:47], v[128:131], v[136:139], v[32:47]
  ds_read_b128 v[148:151], v27
  ds_read_b64_tr_b16 v[156:157], v28 offset:22528
  ds_read_b64_tr_b16 v[158:159], v28 offset:23040
  s_waitcnt lgkmcnt(7)
  v_mfma_f32_32x32x16_bf16 v[48:63], v[132:135], v[136:139], v[48:63]
  ds_read_b128 v[152:155], v27 offset:4096
  s_barrier
  s_waitcnt lgkmcnt(6)
  v_mfma_f32_32x32x16_bf16 v[64:79], v[128:131], v[140:143], v[64:79]
  ds_read_b64_tr_b16 v[160:161], v28 offset:30720
  ds_read_b64_tr_b16 v[162:163], v28 offset:31232
  v_mfma_f32_32x32x16_bf16 v[80:95], v[132:135], v[140:143], v[80:95]
  ds_read_b64_tr_b16 v[164:165], v28 offset:38912
  ds_read_b64_tr_b16 v[166:167], v28 offset:39424
  s_waitcnt lgkmcnt(8)
  v_mfma_f32_32x32x16_bf16 v[96:111], v[144:147], v[128:131], v[96:111]
  v_mfma_f32_32x32x16_bf16 v[112:127], v[144:147], v[132:135], v[112:127]
  s_waitcnt lgkmcnt(5)
  v_mfma_f32_32x32x16_bf16 v[32:47], v[148:151], v[156:159], v[32:47]
  v_add_u32 v24, 40960, v24
  v_add_u32 v25, 40960, v25
  v_add_u32 v26, 40960, v26
  v_add_u32 v27, 40960, v27
  v_add_u32 v28, 40960, v28
  ds_read_b128 v[128:131], v24
  ds_read_b64_tr_b16 v[136:137], v28 offset:16384
  ds_read_b64_tr_b16 v[138:139], v28 offset:16896
  s_waitcnt lgkmcnt(7)
  v_mfma_f32_32x32x16_bf16 v[48:63], v[152:155], v[156:159], v[48:63]
  ds_read_b128 v[132:135], v24 offset:4096
  s_waitcnt lgkmcnt(6)
  v_mfma_f32_32x32x16_bf16 v[64:79], v[148:151], v[160:163], v[64:79]
  ds_read_b64_tr_b16 v[140:141], v28 offset:24576
  ds_read_b64_tr_b16 v[142:143], v28 offset:25088
  v_mfma_f32_32x32x16_bf16 v[80:95], v[152:155], v[160:163], v[80:95]
  ds_read_b64_tr_b16 v[144:145], v28 offset:32768
  ds_read_b64_tr_b16 v[146:147], v28 offset:33280
  s_waitcnt lgkmcnt(8)
  v_mfma_f32_32x32x16_bf16 v[96:111], v[164:167], v[148:151], v[96:111]
  v_mfma_f32_32x32x16_bf16 v[112:127], v[164:167], v[152:155], v[112:127]
  s_waitcnt lgkmcnt(5)
  v_mfma_f32_32x32x16_bf16 v[32:47], v[128:131], v[136:139], v[32:47]
  ds_read_b128 v[148:151], v25
  ds_read_b64_tr_b16 v[156:157], v28 offset:18432
  ds_read_b64_tr_b16 v[158:159], v28 offset:18944
  s_waitcnt lgkmcnt(7)
  v_mfma_f32_32x32x16_bf16 v[48:63], v[132:135], v[136:139], v[48:63]
  ds_read_b128 v[152:155], v25 offset:4096
  s_waitcnt lgkmcnt(6)
  v_mfma_f32_32x32x16_bf16 v[64:79], v[128:131], v[140:143], v[64:79]
  ds_read_b64_tr_b16 v[160:161], v28 offset:26624
  ds_read_b64_tr_b16 v[162:163], v28 offset:27136
  v_mfma_f32_32x32x16_bf16 v[80:95], v[132:135], v[140:143], v[80:95]
  ds_read_b64_tr_b16 v[164:165], v28 offset:34816
  ds_read_b64_tr_b16 v[166:167], v28 offset:35328
  s_waitcnt lgkmcnt(8)
  v_mfma_f32_32x32x16_bf16 v[96:111], v[144:147], v[128:131], v[96:111]
  v_mfma_f32_32x32x16_bf16 v[112:127], v[144:147], v[132:135], v[112:127]
  s_waitcnt lgkmcnt(5)
  v_mfma_f32_32x32x16_bf16 v[32:47], v[148:151], v[156:159], v[32:47]
  ds_read_b128 v[128:131], v26
  ds_read_b64_tr_b16 v[136:137], v28 offset:20480
  ds_read_b64_tr_b16 v[138:139], v28 offset:20992
  s_waitcnt lgkmcnt(7)
  v_mfma_f32_32x32x16_bf16 v[48:63], v[152:155], v[156:159], v[48:63]
  ds_read_b128 v[132:135], v26 offset:4096
  s_waitcnt lgkmcnt(6)
  v_mfma_f32_32x32x16_bf16 v[64:79], v[148:151], v[160:163], v[64:79]
  ds_read_b64_tr_b16 v[140:141], v28 offset:28672
  ds_read_b64_tr_b16 v[142:143], v28 offset:29184
  v_mfma_f32_32x32x16_bf16 v[80:95], v[152:155], v[160:163], v[80:95]
  ds_read_b64_tr_b16 v[144:145], v28 offset:36864
  ds_read_b64_tr_b16 v[146:147], v28 offset:37376
  s_waitcnt lgkmcnt(8)
  v_mfma_f32_32x32x16_bf16 v[96:111], v[164:167], v[148:151], v[96:111]
  v_mfma_f32_32x32x16_bf16 v[112:127], v[164:167], v[152:155], v[112:127]
  s_waitcnt lgkmcnt(5)
  v_mfma_f32_32x32x16_bf16 v[32:47], v[128:131], v[136:139], v[32:47]
  ds_read_b128 v[148:151], v27
  ds_read_b64_tr_b16 v[156:157], v28 offset:22528
  ds_read_b64_tr_b16 v[158:159], v28 offset:23040
  s_waitcnt lgkmcnt(7)
  v_mfma_f32_32x32x16_bf16 v[48:63], v[132:135], v[136:139], v[48:63]
  ds_read_b128 v[152:155], v27 offset:4096
  s_barrier
  s_waitcnt lgkmcnt(6)
  v_mfma_f32_32x32x16_bf16 v[64:79], v[128:131], v[140:143], v[64:79]
  ds_read_b64_tr_b16 v[160:161], v28 offset:30720
  ds_read_b64_tr_b16 v[162:163], v28 offset:31232
  v_mfma_f32_32x32x16_bf16 v[80:95], v[132:135], v[140:143], v[80:95]
  ds_read_b64_tr_b16 v[164:165], v28 offset:38912
  ds_read_b64_tr_b16 v[166:167], v28 offset:39424
  s_waitcnt lgkmcnt(8)
  v_mfma_f32_32x32x16_bf16 v[96:111], v[144:147], v[128:131], v[96:111]
  v_mfma_f32_32x32x16_bf16 v[112:127], v[144:147], v[132:135], v[112:127]
  s_waitcnt lgkmcnt(5)
  v_mfma_f32_32x32x16_bf16 v[32:47], v[148:151], v[156:159], v[32:47]
  v_add_u32 v24, 40960, v24
  v_add_u32 v25, 40960, v25
  v_add_u32 v26, 40960, v26
  v_add_u32 v27, 40960, v27
  v_add_u32 v28, 40960, v28
  ds_read_b128 v[128:131], v24
  ds_read_b64_tr_b16 v[136:137], v28 offset:16384
  ds_read_b64_tr_b16 v[138:139], v28 offset:16896
  s_waitcnt lgkmcnt(7)
  v_mfma_f32_32x32x16_bf16 v[48:63], v[152:155], v[156:159], v[48:63]
  ds_read_b128 v[132:135], v24 offset:4096
  s_waitcnt lgkmcnt(6)
  v_mfma_f32_32x32x16_bf16 v[64:79], v[148:151], v[160:163], v[64:79]
  ds_read_b64_tr_b16 v[140:141], v28 offset:24576
  ds_read_b64_tr_b16 v[142:143], v28 offset:25088
  v_mfma_f32_32x32x16_bf16 v[80:95], v[152:155], v[160:163], v[80:95]
  ds_read_b64_tr_b16 v[144:145], v28 offset:32768
  ds_read_b64_tr_b16 v[146:147], v28 offset:33280
  s_waitcnt lgkmcnt(8)
  v_mfma_f32_32x32x16_bf16 v[96:111], v[164:167], v[148:151], v[96:111]
  v_mfma_f32_32x32x16_bf16 v[112:127], v[164:167], v[152:155], v[112:127]
  s_waitcnt lgkmcnt(5)
  v_mfma_f32_32x32x16_bf16 v[32:47], v[128:131], v[136:139], v[32:47]
  ds_read_b128 v[148:151], v25
  ds_read_b64_tr_b16 v[156:157], v28 offset:18432
  ds_read_b64_tr_b16 v[158:159], v28 offset:18944
  s_waitcnt lgkmcnt(7)
  v_mfma_f32_32x32x16_bf16 v[48:63], v[132:135], v[136:139], v[48:63]
  ds_read_b128 v[152:155], v25 offset:4096
  s_waitcnt lgkmcnt(6)
  v_mfma_f32_32x32x16_bf16 v[64:79], v[128:131], v[140:143], v[64:79]
  ds_read_b64_tr_b16 v[160:161], v28 offset:26624
  ds_read_b64_tr_b16 v[162:163], v28 offset:27136
  v_mfma_f32_32x32x16_bf16 v[80:95], v[132:135], v[140:143], v[80:95]
  ds_read_b64_tr_b16 v[164:165], v28 offset:34816
  ds_read_b64_tr_b16 v[166:167], v28 offset:35328
  s_waitcnt lgkmcnt(8)
  v_mfma_f32_32x32x16_bf16 v[96:111], v[144:147], v[128:131], v[96:111]
  v_mfma_f32_32x32x16_bf16 v[112:127], v[144:147], v[132:135], v[112:127]
  s_waitcnt lgkmcnt(5)
  v_mfma_f32_32x32x16_bf16 v[32:47], v[148:151], v[156:159], v[32:47]
  ds_read_b128 v[128:131], v26
  ds_read_b64_tr_b16 v[136:137], v28 offset:20480
  ds_read_b64_tr_b16 v[138:139], v28 offset:20992
  s_waitcnt lgkmcnt(7)
  v_mfma_f32_32x32x16_bf16 v[48:63], v[152:155], v[156:159], v[48:63]
  ds_read_b128 v[132:135], v26 offset:4096
  s_waitcnt lgkmcnt(6)
  v_mfma_f32_32x32x16_bf16 v[64:79], v[148:151], v[160:163], v[64:79]
  ds_read_b64_tr_b16 v[140:141], v28 offset:28672
  ds_read_b64_tr_b16 v[142:143], v28 offset:29184
  v_mfma_f32_32x32x16_bf16 v[80:95], v[152:155], v[160:163], v[80:95]
  ds_read_b64_tr_b16 v[144:145], v28 offset:36864
  ds_read_b64_tr_b16 v[146:147], v28 offset:37376
  s_waitcnt lgkmcnt(8)
  v_mfma_f32_32x32x16_bf16 v[96:111], v[164:167], v[148:151], v[96:111]
  v_mfma_f32_32x32x16_bf16 v[112:127], v[164:167], v[152:155], v[112:127]
  s_waitcnt lgkmcnt(5)
  v_mfma_f32_32x32x16_bf16 v[32:47], v[128:131], v[136:139], v[32:47]
  ds_read_b128 v[148:151], v27
  ds_read_b64_tr_b16 v[156:157], v28 offset:22528
  ds_read_b64_tr_b16 v[158:159], v28 offset:23040
  s_waitcnt lgkmcnt(7)
  v_mfma_f32_32x32x16_bf16 v[48:63], v[132:135], v[136:139], v[48:63]
  ds_read_b128 v[152:155], v27 offset:4096
  s_barrier
  s_waitcnt lgkmcnt(6)
  v_mfma_f32_32x32x16_bf16 v[64:79], v[128:131], v[140:143], v[64:79]
  ds_read_b64_tr_b16 v[160:161], v28 offset:30720
  ds_read_b64_tr_b16 v[162:163], v28 offset:31232
  v_mfma_f32_32x32x16_bf16 v[80:95], v[132:135], v[140:143], v[80:95]
  ds_read_b64_tr_b16 v[164:165], v28 offset:38912
  ds_read_b64_tr_b16 v[166:167], v28 offset:39424
  s_waitcnt lgkmcnt(8)
  v_mfma_f32_32x32x16_bf16 v[96:111], v[144:147], v[128:131], v[96:111]
  v_mfma_f32_32x32x16_bf16 v[112:127], v[144:147], v[132:135], v[112:127]
  s_waitcnt lgkmcnt(5)
  v_mfma_f32_32x32x16_bf16 v[32:47], v[148:151], v[156:159], v[32:47]
  v_add_u32 v24, 40960, v24
  v_add_u32 v25, 40960, v25
  v_add_u32 v26, 40960, v26
  v_add_u32 v27, 40960, v27
  v_add_u32 v28, 40960, v28
  ds_read_b128 v[128:131], v24
  ds_read_b64_tr_b16 v[136:137], v28 offset:16384
  ds_read_b64_tr_b16 v[138:139], v28 offset:16896
  s_waitcnt lgkmcnt(7)
  v_mfma_f32_32x32x16_bf16 v[48:63], v[152:155], v[156:159], v[48:63]
  ds_read_b128 v[132:135], v24 offset:4096
  s_waitcnt lgkmcnt(6)
  v_mfma_f32_32x32x16_bf16 v[64:79], v[148:151], v[160:163], v[64:79]
  ds_read_b64_tr_b16 v[140:141], v28 offset:24576
  ds_read_b64_tr_b16 v[142:143], v28 offset:25088
  v_mfma_f32_32x32x16_bf16 v[80:95], v[152:155], v[160:163], v[80:95]
  ds_read_b64_tr_b16 v[144:145], v28 offset:32768
  ds_read_b64_tr_b16 v[146:147], v28 offset:33280
  s_waitcnt lgkmcnt(8)
  v_mfma_f32_32x32x16_bf16 v[96:111], v[164:167], v[148:151], v[96:111]
  v_mfma_f32_32x32x16_bf16 v[112:127], v[164:167], v[152:155], v[112:127]
  s_waitcnt lgkmcnt(5)
  v_mfma_f32_32x32x16_bf16 v[32:47], v[128:131], v[136:139], v[32:47]
  ds_read_b128 v[148:151], v25
  ds_read_b64_tr_b16 v[156:157], v28 offset:18432
  ds_read_b64_tr_b16 v[158:159], v28 offset:18944
  s_waitcnt lgkmcnt(7)
  v_mfma_f32_32x32x16_bf16 v[48:63], v[132:135], v[136:139], v[48:63]
  ds_read_b128 v[152:155], v25 offset:4096
  s_waitcnt lgkmcnt(6)
  v_mfma_f32_32x32x16_bf16 v[64:79], v[128:131], v[140:143], v[64:79]
  ds_read_b64_tr_b16 v[160:161], v28 offset:26624
  ds_read_b64_tr_b16 v[162:163], v28 offset:27136
  v_mfma_f32_32x32x16_bf16 v[80:95], v[132:135], v[140:143], v[80:95]
  ds_read_b64_tr_b16 v[164:165], v28 offset:34816
  ds_read_b64_tr_b16 v[166:167], v28 offset:35328
  s_waitcnt lgkmcnt(8)
  v_mfma_f32_32x32x16_bf16 v[96:111], v[144:147], v[128:131], v[96:111]
  v_mfma_f32_32x32x16_bf16 v[112:127], v[144:147], v[132:135], v[112:127]
  s_waitcnt lgkmcnt(5)
  v_mfma_f32_32x32x16_bf16 v[32:47], v[148:151], v[156:159], v[32:47]
  ds_read_b128 v[128:131], v26
  ds_read_b64_tr_b16 v[136:137], v28 offset:20480
  ds_read_b64_tr_b16 v[138:139], v28 offset:20992
  s_waitcnt lgkmcnt(7)
  v_mfma_f32_32x32x16_bf16 v[48:63], v[152:155], v[156:159], v[48:63]
  ds_read_b128 v[132:135], v26 offset:4096
  s_waitcnt lgkmcnt(6)
  v_mfma_f32_32x32x16_bf16 v[64:79], v[148:151], v[160:163], v[64:79]
  ds_read_b64_tr_b16 v[140:141], v28 offset:28672
  ds_read_b64_tr_b16 v[142:143], v28 offset:29184
  v_mfma_f32_32x32x16_bf16 v[80:95], v[152:155], v[160:163], v[80:95]
  ds_read_b64_tr_b16 v[144:145], v28 offset:36864
  ds_read_b64_tr_b16 v[146:147], v28 offset:37376
  s_waitcnt lgkmcnt(8)
  v_mfma_f32_32x32x16_bf16 v[96:111], v[164:167], v[148:151], v[96:111]
  v_mfma_f32_32x32x16_bf16 v[112:127], v[164:167], v[152:155], v[112:127]
  s_waitcnt lgkmcnt(5)
  v_mfma_f32_32x32x16_bf16 v[32:47], v[128:131], v[136:139], v[32:47]
  ds_read_b128 v[148:151], v27
  ds_read_b64_tr_b16 v[156:157], v28 offset:22528
  ds_read_b64_tr_b16 v[158:159], v28 offset:23040
  s_waitcnt lgkmcnt(7)
  v_mfma_f32_32x32x16_bf16 v[48:63], v[132:135], v[136:139], v[48:63]
  ds_read_b128 v[152:155], v27 offset:4096
  s_barrier
  s_waitcnt lgkmcnt(6)
  v_mfma_f32_32x32x16_bf16 v[64:79], v[128:131], v[140:143], v[64:79]
  ds_read_b64_tr_b16 v[160:161], v28 offset:30720
  ds_read_b64_tr_b16 v[162:163], v28 offset:31232
  v_mfma_f32_32x32x16_bf16 v[80:95], v[132:135], v[140:143], v[80:95]
  ds_read_b64_tr_b16 v[164:165], v28 offset:38912
  ds_read_b64_tr_b16 v[166:167], v28 offset:39424
  s_waitcnt lgkmcnt(8)
  v_mfma_f32_32x32x16_bf16 v[96:111], v[144:147], v[128:131], v[96:111]
  v_mfma_f32_32x32x16_bf16 v[112:127], v[144:147], v[132:135], v[112:127]
  s_waitcnt lgkmcnt(5)
  v_mfma_f32_32x32x16_bf16 v[32:47], v[148:151], v[156:159], v[32:47]
  v_subrev_u32 v24, 122880, v24
  v_subrev_u32 v25, 122880, v25
  v_subrev_u32 v26, 122880, v26
  v_subrev_u32 v27, 122880, v27
  v_subrev_u32 v28, 122880, v28
  ds_read_b128 v[128:131], v24
  ds_read_b64_tr_b16 v[136:137], v28 offset:16384
  ds_read_b64_tr_b16 v[138:139], v28 offset:16896
  s_waitcnt lgkmcnt(7)
  v_mfma_f32_32x32x16_bf16 v[48:63], v[152:155], v[156:159], v[48:63]
  ds_read_b128 v[132:135], v24 offset:4096
  s_waitcnt lgkmcnt(6)
  v_mfma_f32_32x32x16_bf16 v[64:79], v[148:151], v[160:163], v[64:79]
  ds_read_b64_tr_b16 v[140:141], v28 offset:24576
  ds_read_b64_tr_b16 v[142:143], v28 offset:25088
  v_mfma_f32_32x32x16_bf16 v[80:95], v[152:155], v[160:163], v[80:95]
  ds_read_b64_tr_b16 v[144:145], v28 offset:32768
  ds_read_b64_tr_b16 v[146:147], v28 offset:33280
  s_waitcnt lgkmcnt(8)
  v_mfma_f32_32x32x16_bf16 v[96:111], v[164:167], v[148:151], v[96:111]
  v_mfma_f32_32x32x16_bf16 v[112:127], v[164:167], v[152:155], v[112:127]
  s_waitcnt lgkmcnt(5)
  v_mfma_f32_32x32x16_bf16 v[32:47], v[128:131], v[136:139], v[32:47]
  ds_read_b128 v[148:151], v25
  ds_read_b64_tr_b16 v[156:157], v28 offset:18432
  ds_read_b64_tr_b16 v[158:159], v28 offset:18944
  s_waitcnt lgkmcnt(7)
  v_mfma_f32_32x32x16_bf16 v[48:63], v[132:135], v[136:139], v[48:63]
  ds_read_b128 v[152:155], v25 offset:4096
  s_waitcnt lgkmcnt(6)
  v_mfma_f32_32x32x16_bf16 v[64:79], v[128:131], v[140:143], v[64:79]
  ds_read_b64_tr_b16 v[160:161], v28 offset:26624
  ds_read_b64_tr_b16 v[162:163], v28 offset:27136
  v_mfma_f32_32x32x16_bf16 v[80:95], v[132:135], v[140:143], v[80:95]
  ds_read_b64_tr_b16 v[164:165], v28 offset:34816
  ds_read_b64_tr_b16 v[166:167], v28 offset:35328
  s_waitcnt lgkmcnt(8)
  v_mfma_f32_32x32x16_bf16 v[96:111], v[144:147], v[128:131], v[96:111]
  v_mfma_f32_32x32x16_bf16 v[112:127], v[144:147], v[132:135], v[112:127]
  s_waitcnt lgkmcnt(5)
  v_mfma_f32_32x32x16_bf16 v[32:47], v[148:151], v[156:159], v[32:47]
  ds_read_b128 v[128:131], v26
  ds_read_b64_tr_b16 v[136:137], v28 offset:20480
  ds_read_b64_tr_b16 v[138:139], v28 offset:20992
  s_waitcnt lgkmcnt(7)
  v_mfma_f32_32x32x16_bf16 v[48:63], v[152:155], v[156:159], v[48:63]
  ds_read_b128 v[132:135], v26 offset:4096
  s_waitcnt lgkmcnt(6)
  v_mfma_f32_32x32x16_bf16 v[64:79], v[148:151], v[160:163], v[64:79]
  ds_read_b64_tr_b16 v[140:141], v28 offset:28672
  ds_read_b64_tr_b16 v[142:143], v28 offset:29184
  v_mfma_f32_32x32x16_bf16 v[80:95], v[152:155], v[160:163], v[80:95]
  ds_read_b64_tr_b16 v[144:145], v28 offset:36864
  ds_read_b64_tr_b16 v[146:147], v28 offset:37376
  s_waitcnt lgkmcnt(8)
  v_mfma_f32_32x32x16_bf16 v[96:111], v[164:167], v[148:151], v[96:111]
  v_mfma_f32_32x32x16_bf16 v[112:127], v[164:167], v[152:155], v[112:127]
  s_waitcnt lgkmcnt(5)
  v_mfma_f32_32x32x16_bf16 v[32:47], v[128:131], v[136:139], v[32:47]
  ds_read_b128 v[148:151], v27
  ds_read_b64_tr_b16 v[156:157], v28 offset:22528
  ds_read_b64_tr_b16 v[158:159], v28 offset:23040
  s_waitcnt lgkmcnt(7)
  v_mfma_f32_32x32x16_bf16 v[48:63], v[132:135], v[136:139], v[48:63]
  ds_read_b128 v[152:155], v27 offset:4096
  s_barrier
  s_waitcnt lgkmcnt(6)
  v_mfma_f32_32x32x16_bf16 v[64:79], v[128:131], v[140:143], v[64:79]
  ds_read_b64_tr_b16 v[160:161], v28 offset:30720
  ds_read_b64_tr_b16 v[162:163], v28 offset:31232
  v_mfma_f32_32x32x16_bf16 v[80:95], v[132:135], v[140:143], v[80:95]
  ds_read_b64_tr_b16 v[164:165], v28 offset:38912
  ds_read_b64_tr_b16 v[166:167], v28 offset:39424
  s_waitcnt lgkmcnt(8)
  v_mfma_f32_32x32x16_bf16 v[96:111], v[144:147], v[128:131], v[96:111]
  v_mfma_f32_32x32x16_bf16 v[112:127], v[144:147], v[132:135], v[112:127]
  s_waitcnt lgkmcnt(5)
  v_mfma_f32_32x32x16_bf16 v[32:47], v[148:151], v[156:159], v[32:47]
  v_add_u32 v24, 40960, v24
  v_add_u32 v25, 40960, v25
  v_add_u32 v26, 40960, v26
  v_add_u32 v27, 40960, v27
  v_add_u32 v28, 40960, v28
  ds_read_b128 v[128:131], v24
  ds_read_b64_tr_b16 v[136:137], v28 offset:16384
  ds_read_b64_tr_b16 v[138:139], v28 offset:16896
  s_waitcnt lgkmcnt(7)
  v_mfma_f32_32x32x16_bf16 v[48:63], v[152:155], v[156:159], v[48:63]
  ds_read_b128 v[132:135], v24 offset:4096
  s_waitcnt lgkmcnt(6)
  v_mfma_f32_32x32x16_bf16 v[64:79], v[148:151], v[160:163], v[64:79]
  ds_read_b64_tr_b16 v[140:141], v28 offset:24576
  ds_read_b64_tr_b16 v[142:143], v28 offset:25088
  v_mfma_f32_32x32x16_bf16 v[80:95], v[152:155], v[160:163], v[80:95]
  ds_read_b64_tr_b16 v[144:145], v28 offset:32768
  ds_read_b64_tr_b16 v[146:147], v28 offset:33280
  s_waitcnt lgkmcnt(8)
  v_mfma_f32_32x32x16_bf16 v[96:111], v[164:167], v[148:151], v[96:111]
  v_mfma_f32_32x32x16_bf16 v[112:127], v[164:167], v[152:155], v[112:127]
  s_waitcnt lgkmcnt(5)
  v_mfma_f32_32x32x16_bf16 v[32:47], v[128:131], v[136:139], v[32:47]
  ds_read_b128 v[148:151], v25
  ds_read_b64_tr_b16 v[156:157], v28 offset:18432
  ds_read_b64_tr_b16 v[158:159], v28 offset:18944
  s_waitcnt lgkmcnt(7)
  v_mfma_f32_32x32x16_bf16 v[48:63], v[132:135], v[136:139], v[48:63]
  ds_read_b128 v[152:155], v25 offset:4096
  s_waitcnt lgkmcnt(6)
  v_mfma_f32_32x32x16_bf16 v[64:79], v[128:131], v[140:143], v[64:79]
  ds_read_b64_tr_b16 v[160:161], v28 offset:26624
  ds_read_b64_tr_b16 v[162:163], v28 offset:27136
  v_mfma_f32_32x32x16_bf16 v[80:95], v[132:135], v[140:143], v[80:95]
  ds_read_b64_tr_b16 v[164:165], v28 offset:34816
  ds_read_b64_tr_b16 v[166:167], v28 offset:35328
  s_waitcnt lgkmcnt(8)
  v_mfma_f32_32x32x16_bf16 v[96:111], v[144:147], v[128:131], v[96:111]
  v_mfma_f32_32x32x16_bf16 v[112:127], v[144:147], v[132:135], v[112:127]
  s_waitcnt lgkmcnt(5)
  v_mfma_f32_32x32x16_bf16 v[32:47], v[148:151], v[156:159], v[32:47]
  ds_read_b128 v[128:131], v26
  ds_read_b64_tr_b16 v[136:137], v28 offset:20480
  ds_read_b64_tr_b16 v[138:139], v28 offset:20992
  s_waitcnt lgkmcnt(7)
  v_mfma_f32_32x32x16_bf16 v[48:63], v[152:155], v[156:159], v[48:63]
  ds_read_b128 v[132:135], v26 offset:4096
  s_waitcnt lgkmcnt(6)
  v_mfma_f32_32x32x16_bf16 v[64:79], v[148:151], v[160:163], v[64:79]
  ds_read_b64_tr_b16 v[140:141], v28 offset:28672
  ds_read_b64_tr_b16 v[142:143], v28 offset:29184
  v_mfma_f32_32x32x16_bf16 v[80:95], v[152:155], v[160:163], v[80:95]
  ds_read_b64_tr_b16 v[144:145], v28 offset:36864
  ds_read_b64_tr_b16 v[146:147], v28 offset:37376
  s_waitcnt lgkmcnt(8)
  v_mfma_f32_32x32x16_bf16 v[96:111], v[164:167], v[148:151], v[96:111]
  v_mfma_f32_32x32x16_bf16 v[112:127], v[164:167], v[152:155], v[112:127]
  s_waitcnt lgkmcnt(5)
  v_mfma_f32_32x32x16_bf16 v[32:47], v[128:131], v[136:139], v[32:47]
  ds_read_b128 v[148:151], v27
  ds_read_b64_tr_b16 v[156:157], v28 offset:22528
  ds_read_b64_tr_b16 v[158:159], v28 offset:23040
  s_waitcnt lgkmcnt(7)
  v_mfma_f32_32x32x16_bf16 v[48:63], v[132:135], v[136:139], v[48:63]
  ds_read_b128 v[152:155], v27 offset:4096
  s_barrier
  s_waitcnt lgkmcnt(6)
  v_mfma_f32_32x32x16_bf16 v[64:79], v[128:131], v[140:143], v[64:79]
  ds_read_b64_tr_b16 v[160:161], v28 offset:30720
  ds_read_b64_tr_b16 v[162:163], v28 offset:31232
  v_mfma_f32_32x32x16_bf16 v[80:95], v[132:135], v[140:143], v[80:95]
  ds_read_b64_tr_b16 v[164:165], v28 offset:38912
  ds_read_b64_tr_b16 v[166:167], v28 offset:39424
  s_waitcnt lgkmcnt(8)
  v_mfma_f32_32x32x16_bf16 v[96:111], v[144:147], v[128:131], v[96:111]
  v_mfma_f32_32x32x16_bf16 v[112:127], v[144:147], v[132:135], v[112:127]
  s_waitcnt lgkmcnt(5)
  v_mfma_f32_32x32x16_bf16 v[32:47], v[148:151], v[156:159], v[32:47]
  v_add_u32 v24, 40960, v24
  v_add_u32 v25, 40960, v25
  v_add_u32 v26, 40960, v26
  v_add_u32 v27, 40960, v27
  v_add_u32 v28, 40960, v28
  ds_read_b128 v[200:203], v24
  ds_read_b64_tr_b16 v[168:169], v28 offset:32768
  ds_read_b64_tr_b16 v[170:171], v28 offset:33280
  s_waitcnt lgkmcnt(7)
  v_mfma_f32_32x32x16_bf16 v[48:63], v[152:155], v[156:159], v[48:63]
  ds_read_b128 v[204:207], v24 offset:4096
  s_waitcnt lgkmcnt(6)
  v_mfma_f32_32x32x16_bf16 v[64:79], v[148:151], v[160:163], v[64:79]
  ds_read_b128 v[208:211], v25
  ds_read_b64_tr_b16 v[172:173], v28 offset:34816
  v_mfma_f32_32x32x16_bf16 v[80:95], v[152:155], v[160:163], v[80:95]
  ds_read_b64_tr_b16 v[174:175], v28 offset:35328
  ds_read_b128 v[212:215], v25 offset:4096
  s_waitcnt lgkmcnt(8)
  v_mfma_f32_32x32x16_bf16 v[96:111], v[164:167], v[148:151], v[96:111]
  v_mfma_f32_32x32x16_bf16 v[112:127], v[164:167], v[152:155], v[112:127]
  s_waitcnt lgkmcnt(5)
  v_mfma_f32_32x32x16_bf16 v[96:111], v[168:171], v[200:203], v[96:111]
  ds_read_b128 v[216:219], v26
  ds_read_b64_tr_b16 v[176:177], v28 offset:36864
  ds_read_b64_tr_b16 v[178:179], v28 offset:37376
  s_waitcnt lgkmcnt(7)
  v_mfma_f32_32x32x16_bf16 v[112:127], v[168:171], v[204:207], v[112:127]
  ds_read_b128 v[220:223], v26 offset:4096
  s_waitcnt lgkmcnt(5)
  v_mfma_f32_32x32x16_bf16 v[96:111], v[172:175], v[208:211], v[96:111]
  ds_read_b128 v[224:227], v27
  ds_read_b64_tr_b16 v[180:181], v28 offset:38912
  ds_read_b64_tr_b16 v[182:183], v28 offset:39424
  s_waitcnt lgkmcnt(7)
  v_mfma_f32_32x32x16_bf16 v[112:127], v[172:175], v[212:215], v[112:127]
  ds_read_b128 v[228:231], v27 offset:4096
  s_waitcnt lgkmcnt(5)
  v_mfma_f32_32x32x16_bf16 v[96:111], v[176:179], v[216:219], v[96:111]
  ds_read_b64_tr_b16 v[128:129], v28 offset:16384
  ds_read_b64_tr_b16 v[130:131], v28 offset:16896
  s_waitcnt lgkmcnt(6)
  v_mfma_f32_32x32x16_bf16 v[112:127], v[176:179], v[220:223], v[112:127]
  s_barrier
  s_waitcnt lgkmcnt(3)
  v_mfma_f32_32x32x16_bf16 v[96:111], v[180:183], v[224:227], v[96:111]
  ds_read_b64_tr_b16 v[132:133], v28 offset:18432
  ds_read_b64_tr_b16 v[134:135], v28 offset:18944
  s_waitcnt lgkmcnt(4)
  v_mfma_f32_32x32x16_bf16 v[112:127], v[180:183], v[228:231], v[112:127]
  s_waitcnt lgkmcnt(2)
  v_mfma_f32_32x32x16_bf16 v[32:47], v[200:203], v[128:131], v[32:47]
  ds_read_b64_tr_b16 v[136:137], v28 offset:20480
  ds_read_b64_tr_b16 v[138:139], v28 offset:20992
  v_mfma_f32_32x32x16_bf16 v[48:63], v[204:207], v[128:131], v[48:63]
  s_waitcnt lgkmcnt(2)
  v_mfma_f32_32x32x16_bf16 v[32:47], v[208:211], v[132:135], v[32:47]
  ds_read_b64_tr_b16 v[140:141], v28 offset:22528
  ds_read_b64_tr_b16 v[142:143], v28 offset:23040
  v_cvt_pk_bf16_f32 v232, v96, v97
  v_cvt_pk_bf16_f32 v233, v98, v99
  v_cvt_pk_bf16_f32 v234, v100, v101
  v_cvt_pk_bf16_f32 v235, v102, v103
  ds_write_b128 v9, v[232:235] offset:0
  v_mfma_f32_32x32x16_bf16 v[48:63], v[212:215], v[132:135], v[48:63]
  v_cvt_pk_bf16_f32 v236, v104, v105
  v_cvt_pk_bf16_f32 v237, v106, v107
  v_cvt_pk_bf16_f32 v238, v108, v109
  v_cvt_pk_bf16_f32 v239, v110, v111
  ds_write_b128 v9, v[236:239] offset:1024
  s_waitcnt lgkmcnt(4)
  v_mfma_f32_32x32x16_bf16 v[32:47], v[216:219], v[136:139], v[32:47]
  ds_read_b64_tr_b16 v[144:145], v28 offset:24576
  ds_read_b64_tr_b16 v[146:147], v28 offset:25088
  v_cvt_pk_bf16_f32 v240, v112, v113
  v_cvt_pk_bf16_f32 v241, v114, v115
  v_cvt_pk_bf16_f32 v242, v116, v117
  v_cvt_pk_bf16_f32 v243, v118, v119
  ds_write_b128 v9, v[240:243] offset:2048
  v_mfma_f32_32x32x16_bf16 v[48:63], v[220:223], v[136:139], v[48:63]
  v_cvt_pk_bf16_f32 v244, v120, v121
  v_cvt_pk_bf16_f32 v245, v122, v123
  v_cvt_pk_bf16_f32 v246, v124, v125
  v_cvt_pk_bf16_f32 v247, v126, v127
  ds_write_b128 v9, v[244:247] offset:3072
  s_waitcnt lgkmcnt(6)
  v_mfma_f32_32x32x16_bf16 v[32:47], v[224:227], v[140:143], v[32:47]
  ds_read_b64_tr_b16 v[148:149], v28 offset:26624
  ds_read_b64_tr_b16 v[150:151], v28 offset:27136
  v_mfma_f32_32x32x16_bf16 v[48:63], v[228:231], v[140:143], v[48:63]
  s_waitcnt lgkmcnt(2)
  s_barrier
  ds_read_b32 v19, v18
  v_mfma_f32_32x32x16_bf16 v[64:79], v[200:203], v[144:147], v[64:79]
  ds_read_b64_tr_b16 v[152:153], v28 offset:28672
  ds_read_b64_tr_b16 v[154:155], v28 offset:29184
  v_mfma_f32_32x32x16_bf16 v[80:95], v[204:207], v[144:147], v[80:95]
  s_waitcnt lgkmcnt(3)
  v_mfma_f32_32x32x16_bf16 v[64:79], v[208:211], v[148:151], v[64:79]
  ds_read_b64_tr_b16 v[156:157], v28 offset:30720
  ds_read_b64_tr_b16 v[158:159], v28 offset:31232
  v_mul_f32 v96, s46, v32
  v_mul_f32 v97, s46, v33
  v_mul_f32 v98, s46, v34
  v_mfma_f32_32x32x16_bf16 v[80:95], v[212:215], v[148:151], v[80:95]
  v_mul_f32 v99, s46, v35
  v_mul_f32 v100, s46, v36
  v_mul_f32 v101, s46, v37
  s_waitcnt lgkmcnt(2)
  v_mfma_f32_32x32x16_bf16 v[64:79], v[216:219], v[152:155], v[64:79]
  v_mul_f32 v102, s46, v38
  v_mul_f32 v103, s46, v39
  v_mul_f32 v104, s46, v40
  v_mfma_f32_32x32x16_bf16 v[80:95], v[220:223], v[152:155], v[80:95]
  v_mul_f32 v105, s46, v41
  v_mul_f32 v106, s46, v42
  v_mul_f32 v107, s46, v43
  s_waitcnt lgkmcnt(0)
  v_mfma_f32_32x32x16_bf16 v[64:79], v[224:227], v[156:159], v[64:79]
  v_mul_f32 v108, s46, v44
  v_mul_f32 v109, s46, v45
  v_mul_f32 v110, s46, v46
  v_mfma_f32_32x32x16_bf16 v[80:95], v[228:231], v[156:159], v[80:95]
  v_mul_f32 v111, s46, v47
  v_mul_f32 v112, s46, v48
  v_mul_f32 v113, s46, v49
  s_setprio 0
  v_mul_f32 v114, s46, v50
  v_mul_f32 v115, s46, v51
  v_mul_f32 v116, s46, v52
  v_mul_f32 v117, s46, v53
  v_mul_f32 v118, s46, v54
  v_mul_f32 v119, s46, v55
  v_mul_f32 v120, s46, v56
  v_mul_f32 v121, s46, v57
  v_mul_f32 v122, s46, v58
  v_mul_f32 v123, s46, v59
  v_mul_f32 v124, s46, v60
  v_mul_f32 v125, s46, v61
  v_mul_f32 v126, s46, v62
  v_mul_f32 v127, s46, v63
  v_exp_f32 v96, v96 clamp
  v_exp_f32 v97, v97 clamp
  v_pk_add_f32 v[32:33], v[32:33], s[68:69]
  v_exp_f32 v98, v98 clamp
  v_exp_f32 v99, v99 clamp
  v_pk_add_f32 v[34:35], v[34:35], s[68:69]
  v_exp_f32 v100, v100 clamp
  v_exp_f32 v101, v101 clamp
  v_pk_add_f32 v[36:37], v[36:37], s[68:69]
  v_exp_f32 v102, v102 clamp
  v_exp_f32 v103, v103 clamp
  v_pk_add_f32 v[38:39], v[38:39], s[68:69]
  v_exp_f32 v104, v104 clamp
  v_exp_f32 v105, v105 clamp
  v_pk_add_f32 v[40:41], v[40:41], s[68:69]
  v_exp_f32 v106, v106 clamp
  v_exp_f32 v107, v107 clamp
  v_pk_add_f32 v[42:43], v[42:43], s[68:69]
  v_exp_f32 v108, v108 clamp
  v_exp_f32 v109, v109 clamp
  v_pk_add_f32 v[44:45], v[44:45], s[68:69]
  v_exp_f32 v110, v110 clamp
  v_exp_f32 v111, v111 clamp
  v_pk_add_f32 v[46:47], v[46:47], s[68:69]
  v_exp_f32 v112, v112 clamp
  v_exp_f32 v113, v113 clamp
  v_pk_add_f32 v[48:49], v[48:49], s[68:69]
  v_exp_f32 v114, v114 clamp
  v_exp_f32 v115, v115 clamp
  v_pk_add_f32 v[50:51], v[50:51], s[68:69]
  v_exp_f32 v116, v116 clamp
  v_exp_f32 v117, v117 clamp
  v_pk_add_f32 v[52:53], v[52:53], s[68:69]
  v_exp_f32 v118, v118 clamp
  v_exp_f32 v119, v119 clamp
  v_pk_add_f32 v[54:55], v[54:55], s[68:69]
  v_exp_f32 v120, v120 clamp
  v_exp_f32 v121, v121 clamp
  v_pk_add_f32 v[56:57], v[56:57], s[68:69]
  v_exp_f32 v122, v122 clamp
  v_exp_f32 v123, v123 clamp
  v_pk_add_f32 v[58:59], v[58:59], s[68:69]
  v_exp_f32 v124, v124 clamp
  v_exp_f32 v125, v125 clamp
  v_pk_add_f32 v[60:61], v[60:61], s[68:69]
  v_exp_f32 v126, v126 clamp
  v_exp_f32 v127, v127 clamp
  v_pk_add_f32 v[62:63], v[62:63], s[68:69]
  v_max_f32 v96, v96, v32
  v_max_f32 v97, v97, v33
  v_pk_add_f32 v[96:97], v[96:97], s[72:73]
  v_max_f32 v98, v98, v34
  v_max_f32 v99, v99, v35
  v_pk_add_f32 v[98:99], v[98:99], s[72:73]
  v_max_f32 v100, v100, v36
  v_max_f32 v101, v101, v37
  v_pk_add_f32 v[100:101], v[100:101], s[72:73]
  v_max_f32 v102, v102, v38
  v_max_f32 v103, v103, v39
  v_pk_add_f32 v[102:103], v[102:103], s[72:73]
  v_max_f32 v104, v104, v40
  v_max_f32 v105, v105, v41
  v_pk_add_f32 v[104:105], v[104:105], s[72:73]
  v_max_f32 v106, v106, v42
  v_max_f32 v107, v107, v43
  v_pk_add_f32 v[106:107], v[106:107], s[72:73]
  v_max_f32 v108, v108, v44
  v_max_f32 v109, v109, v45
  v_pk_add_f32 v[108:109], v[108:109], s[72:73]
  v_max_f32 v110, v110, v46
  v_max_f32 v111, v111, v47
  v_pk_add_f32 v[110:111], v[110:111], s[72:73]
  v_max_f32 v112, v112, v48
  v_max_f32 v113, v113, v49
  v_pk_add_f32 v[112:113], v[112:113], s[72:73]
  v_max_f32 v114, v114, v50
  v_max_f32 v115, v115, v51
  v_pk_add_f32 v[114:115], v[114:115], s[72:73]
  v_max_f32 v116, v116, v52
  v_max_f32 v117, v117, v53
  v_pk_add_f32 v[116:117], v[116:117], s[72:73]
  v_max_f32 v118, v118, v54
  v_max_f32 v119, v119, v55
  v_pk_add_f32 v[118:119], v[118:119], s[72:73]
  v_max_f32 v120, v120, v56
  v_max_f32 v121, v121, v57
  v_pk_add_f32 v[120:121], v[120:121], s[72:73]
  v_max_f32 v122, v122, v58
  v_max_f32 v123, v123, v59
  v_pk_add_f32 v[122:123], v[122:123], s[72:73]
  v_max_f32 v124, v124, v60
  v_max_f32 v125, v125, v61
  v_pk_add_f32 v[124:125], v[124:125], s[72:73]
  v_max_f32 v126, v126, v62
  v_max_f32 v127, v127, v63
  v_pk_add_f32 v[126:127], v[126:127], s[72:73]
  v_cvt_pk_bf16_f32 v168, v96, v97
  v_cvt_pk_bf16_f32 v169, v98, v99
  v_cvt_pk_bf16_f32 v170, v100, v101
  v_cvt_pk_bf16_f32 v171, v102, v103
  v_cvt_pk_bf16_f32 v172, v104, v105
  v_cvt_pk_bf16_f32 v173, v106, v107
  v_cvt_pk_bf16_f32 v174, v108, v109
  v_cvt_pk_bf16_f32 v175, v110, v111
  v_cvt_pk_bf16_f32 v176, v112, v113
  v_cvt_pk_bf16_f32 v177, v114, v115
  v_cvt_pk_bf16_f32 v178, v116, v117
  v_cvt_pk_bf16_f32 v179, v118, v119
  v_cvt_pk_bf16_f32 v180, v120, v121
  v_cvt_pk_bf16_f32 v181, v122, v123
  v_cvt_pk_bf16_f32 v182, v124, v125
  v_cvt_pk_bf16_f32 v183, v126, v127
  s_mov_b32 exec_lo, 0xefffffff
  s_mov_b32 exec_hi, 0xefffffff
  v_cvt_pk_bf16_f32 v184, v64, v65
  v_cvt_pk_bf16_f32 v185, v66, v67
  v_cvt_pk_bf16_f32 v186, v68, v69
  v_cvt_pk_bf16_f32 v187, v70, v71
  v_cvt_pk_bf16_f32 v188, v72, v73
  v_cvt_pk_bf16_f32 v189, v74, v75
  v_cvt_pk_bf16_f32 v190, v76, v77
  v_cvt_pk_bf16_f32 v191, v78, v79
  v_cvt_pk_bf16_f32 v192, v80, v81
  v_cvt_pk_bf16_f32 v193, v82, v83
  v_cvt_pk_bf16_f32 v194, v84, v85
  v_cvt_pk_bf16_f32 v195, v86, v87
  v_cvt_pk_bf16_f32 v196, v88, v89
  v_cvt_pk_bf16_f32 v197, v90, v91
  v_cvt_pk_bf16_f32 v198, v92, v93
  v_cvt_pk_bf16_f32 v199, v94, v95
  s_mov_b64 exec, -1
  v_mfma_f32_32x32x16_bf16 v[32:47], v[184:187], v[168:171], 0
  v_mfma_f32_32x32x16_bf16 v[32:47], v[188:191], v[172:175], v[32:47]
  v_mfma_f32_32x32x16_bf16 v[32:47], v[192:195], v[176:179], v[32:47]
  v_mfma_f32_32x32x16_bf16 v[32:47], v[196:199], v[180:183], v[32:47]
  s_xor_b32 s9, s8, 4096
  v_lshl_add_u32 v9, v1, 4, s9
  v_lshlrev_b32 v11, 2, v2
  v_lshl_add_u32 v11, v3, 9, v11
  s_lshl_b32 s12, s5, 13
  s_lshl_b32 s9, s11, 12
  s_add_u32 s12, s12, s9
  s_lshl_b32 s9, s10, 11
  s_add_u32 s12, s12, s9
  s_add_u32 s12, s12, 4194304
  s_lshl_b32 s9, s3, 2
  s_add_u32 s9, s9, 35864
  v_mov_b32 v12, s9
  v_xor_b32 v13, 4, v12
  s_waitcnt lgkmcnt(0)
  v_readfirstlane_b32 s74, v19
  s_nop 4
  s_cmp_lg_u32 s10, 0
  s_cbranch_scc1 Lkx1_4
  ds_write_b128 v8, v[40:43]
  ds_write_b128 v8, v[44:47] offset:1024
  s_branch Lkxj_5
Lkx1_4:
  ds_write_b128 v8, v[32:35]
  ds_write_b128 v8, v[36:39] offset:1024
  v_mov_b32 v32, v40
  v_mov_b32 v33, v41
  v_mov_b32 v34, v42
  v_mov_b32 v35, v43
  v_mov_b32 v36, v44
  v_mov_b32 v37, v45
  v_mov_b32 v38, v46
  v_mov_b32 v39, v47
Lkxj_5:
  ds_write_b32 v12, v19
  s_mov_b32 s13, 0
Lkxs_6:
  ds_read_b32 v14, v13
  s_add_u32 s13, s13, 1
  s_waitcnt lgkmcnt(0)
  v_readfirstlane_b32 s9, v14
  s_cmp_ge_u32 s13, 1600000
  s_cselect_b32 s9, s74, s9
  s_cmp_lg_u32 s9, s74
  s_cbranch_scc1 Lkxs_6
  ds_read_b128 v[48:51], v9
  ds_read_b128 v[52:55], v9 offset:1024
  s_waitcnt lgkmcnt(1)
  v_pk_add_f32 v[32:33], v[32:33], v[48:49]
  v_pk_add_f32 v[34:35], v[34:35], v[50:51]
  buffer_atomic_add_f32 v32, v11, s[56:59], s12 offen offset:0
  buffer_atomic_add_f32 v33, v11, s[56:59], s12 offen offset:128
  buffer_atomic_add_f32 v34, v11, s[56:59], s12 offen offset:256
  buffer_atomic_add_f32 v35, v11, s[56:59], s12 offen offset:384
  s_waitcnt lgkmcnt(0)
  v_pk_add_f32 v[36:37], v[36:37], v[52:53]
  v_pk_add_f32 v[38:39], v[38:39], v[54:55]
  buffer_atomic_add_f32 v36, v11, s[56:59], s12 offen offset:1024
  buffer_atomic_add_f32 v37, v11, s[56:59], s12 offen offset:1152
  buffer_atomic_add_f32 v38, v11, s[56:59], s12 offen offset:1280
  buffer_atomic_add_f32 v39, v11, s[56:59], s12 offen offset:1408
  s_setprio 0
  s_lshl_b32 s8, s4, 3
  s_add_u32 s8, s8, s5
  s_lshl_b32 s8, s8, 7
  s_add_u32 s9, s8, 4325376
  v_mov_b32 v26, 1
  s_waitcnt vmcnt(0)
  s_mov_b64 exec, 1
  ds_add_rtn_u32 v27, v18, v26 offset:12
  s_waitcnt lgkmcnt(0)
  v_readfirstlane_b32 s10, v27
  s_nop 0
  s_cmp_lg_u32 s10, 3
  s_cbranch_scc1 Lfl_7
  buffer_store_dword v19, v30, s[56:59], s9 offen sc0 sc1
  ds_write_b32 v18, v19 offset:20
Lfl_7:
  s_mov_b64 exec, -1
  s_branch Lb2_2
Lldr_1:
  v_lshrrev_b32 v8, 3, v1
  v_and_b32 v9, 7, v1
  v_lshrrev_b32 v10, 4, v1
  s_lshl_b32 s8, s4, 7
  s_lshl_b32 s9, s6, 5
  s_add_u32 s8, s8, s9
  v_add_u32 v11, s8, v8
  v_mul_u32_u24 v11, 896, v11
  v_xor_b32 v12, v9, v10
  v_lshl_add_u32 v20, v12, 4, v11
  v_xor_b32 v12, 4, v12
  v_lshl_add_u32 v21, v12, 4, v11
  v_and_b32 v12, 1, v10
  v_lshlrev_b32 v12, 2, v12
  v_xor_b32 v12, v9, v12
  v_lshlrev_b32 v12, 4, v12
  s_lshl_b32 s8, s6, 4
  v_add_u32 v13, s8, v8
  v_mul_u32_u24 v14, 2688, v13
  v_add_u32 v14, v14, v12
  s_mul_i32 s8, s5, 112
  v_add_u32 v22, s8, v14
  s_lshl_b32 s8, s6, 3
  v_add_u32 v14, s8, v8
  v_mul_u32_u24 v14, 896, v14
  v_add_u32 v14, v14, v12
  s_lshl_b32 s8, s5, 7
  v_add_u32 v23, s8, v14
  s_lshl_b32 s14, s6, 10
  s_lshl_b32 s12, s6, 12
  s_lshl_b32 s13, s6, 11
  s_waitcnt lgkmcnt(0)
  s_mov_b32 s48, s34
  s_mov_b32 s49, s35
  s_mov_b32 s50, 1835008
  s_mov_b32 s51, 0x00020000
  s_mov_b32 s52, s36
  s_mov_b32 s53, s37
  s_mov_b32 s54, 1204224
  s_mov_b32 s55, 0x00020000
  s_add_u32 m0, s12, 0
  s_movk_i32 s8, 0
  buffer_load_dwordx4 v20, s[48:51], s8 offen lds
  s_add_u32 m0, s12, 1024
  s_movk_i32 s8, 7168
  buffer_load_dwordx4 v21, s[48:51], s8 offen lds
  s_add_u32 m0, s12, 2048
  s_movk_i32 s8, 14336
  buffer_load_dwordx4 v20, s[48:51], s8 offen lds
  s_add_u32 m0, s12, 3072
  s_movk_i32 s8, 21504
  buffer_load_dwordx4 v21, s[48:51], s8 offen lds
  s_add_u32 m0, s13, 16384
  s_mov_b32 s8, 896
  buffer_load_dwordx4 v22, s[52:55], s8 offen lds
  s_add_u32 m0, s13, 17408
  s_mov_b32 s8, 22400
  buffer_load_dwordx4 v22, s[52:55], s8 offen lds
  s_add_u32 m0, s13, 24576
  s_mov_b32 s8, 1792
  buffer_load_dwordx4 v22, s[52:55], s8 offen lds
  s_add_u32 m0, s13, 25600
  s_mov_b32 s8, 23296
  buffer_load_dwordx4 v22, s[52:55], s8 offen lds
  s_add_u32 m0, s13, 32768
  s_mov_b32 s8, 0
  buffer_load_dwordx4 v22, s[52:55], s8 offen lds
  s_add_u32 m0, s13, 33792
  s_mov_b32 s8, 21504
  buffer_load_dwordx4 v22, s[52:55], s8 offen lds
  s_mov_b32 s56, s44
  s_mov_b32 s57, s45
  s_mov_b32 s58, 16777216
  s_mov_b32 s59, 0x00020000
  s_mov_b32 s60, s38
  s_mov_b32 s61, s39
  s_mov_b32 s62, 401408
  s_mov_b32 s63, 0x00020000
  s_mov_b32 s64, s40
  s_mov_b32 s65, s41
  s_mov_b32 s66, 3670016
  s_mov_b32 s67, 0x00020000
  s_barrier
  s_add_u32 m0, s12, 40960
  s_movk_i32 s8, 128
  buffer_load_dwordx4 v20, s[48:51], s8 offen lds
  s_add_u32 m0, s12, 41984
  s_movk_i32 s8, 7296
  buffer_load_dwordx4 v21, s[48:51], s8 offen lds
  s_add_u32 m0, s12, 43008
  s_movk_i32 s8, 14464
  buffer_load_dwordx4 v20, s[48:51], s8 offen lds
  s_add_u32 m0, s12, 44032
  s_movk_i32 s8, 21632
  buffer_load_dwordx4 v21, s[48:51], s8 offen lds
  s_add_u32 m0, s13, 57344
  s_mov_b32 s8, 172928
  buffer_load_dwordx4 v22, s[52:55], s8 offen lds
  s_add_u32 m0, s13, 58368
  s_mov_b32 s8, 194432
  buffer_load_dwordx4 v22, s[52:55], s8 offen lds
  s_add_u32 m0, s13, 65536
  s_mov_b32 s8, 173824
  buffer_load_dwordx4 v22, s[52:55], s8 offen lds
  s_add_u32 m0, s13, 66560
  s_mov_b32 s8, 195328
  buffer_load_dwordx4 v22, s[52:55], s8 offen lds
  s_add_u32 m0, s13, 73728
  s_mov_b32 s8, 172032
  buffer_load_dwordx4 v22, s[52:55], s8 offen lds
  s_add_u32 m0, s13, 74752
  s_mov_b32 s8, 193536
  buffer_load_dwordx4 v22, s[52:55], s8 offen lds
  s_waitcnt vmcnt(10)
  s_barrier
  s_add_u32 m0, s12, 81920
  s_movk_i32 s8, 256
  buffer_load_dwordx4 v20, s[48:51], s8 offen lds
  s_add_u32 m0, s12, 82944
  s_movk_i32 s8, 7424
  buffer_load_dwordx4 v21, s[48:51], s8 offen lds
  s_add_u32 m0, s12, 83968
  s_movk_i32 s8, 14592
  buffer_load_dwordx4 v20, s[48:51], s8 offen lds
  s_add_u32 m0, s12, 84992
  s_movk_i32 s8, 21760
  buffer_load_dwordx4 v21, s[48:51], s8 offen lds
  s_add_u32 m0, s13, 98304
  s_mov_b32 s8, 344960
  buffer_load_dwordx4 v22, s[52:55], s8 offen lds
  s_add_u32 m0, s13, 99328
  s_mov_b32 s8, 366464
  buffer_load_dwordx4 v22, s[52:55], s8 offen lds
  s_add_u32 m0, s13, 106496
  s_mov_b32 s8, 345856
  buffer_load_dwordx4 v22, s[52:55], s8 offen lds
  s_add_u32 m0, s13, 107520
  s_mov_b32 s8, 367360
  buffer_load_dwordx4 v22, s[52:55], s8 offen lds
  s_add_u32 m0, s13, 114688
  s_mov_b32 s8, 344064
  buffer_load_dwordx4 v22, s[52:55], s8 offen lds
  s_add_u32 m0, s13, 115712
  s_mov_b32 s8, 365568
  buffer_load_dwordx4 v22, s[52:55], s8 offen lds
  s_waitcnt vmcnt(10)
  s_barrier
  s_add_u32 m0, s12, 122880
  s_movk_i32 s8, 384
  buffer_load_dwordx4 v20, s[48:51], s8 offen lds
  s_add_u32 m0, s12, 123904
  s_movk_i32 s8, 7552
  buffer_load_dwordx4 v21, s[48:51], s8 offen lds
  s_add_u32 m0, s12, 124928
  s_movk_i32 s8, 14720
  buffer_load_dwordx4 v20, s[48:51], s8 offen lds
  s_add_u32 m0, s12, 125952
  s_movk_i32 s8, 21888
  buffer_load_dwordx4 v21, s[48:51], s8 offen lds
  s_add_u32 m0, s13, 139264
  s_mov_b32 s8, 516992
  buffer_load_dwordx4 v22, s[52:55], s8 offen lds
  s_add_u32 m0, s13, 140288
  s_mov_b32 s8, 538496
  buffer_load_dwordx4 v22, s[52:55], s8 offen lds
  s_add_u32 m0, s13, 147456
  s_mov_b32 s8, 517888
  buffer_load_dwordx4 v22, s[52:55], s8 offen lds
  s_add_u32 m0, s13, 148480
  s_mov_b32 s8, 539392
  buffer_load_dwordx4 v22, s[52:55], s8 offen lds
  s_add_u32 m0, s13, 155648
  s_mov_b32 s8, 516096
  buffer_load_dwordx4 v22, s[52:55], s8 offen lds
  s_add_u32 m0, s13, 156672
  s_mov_b32 s8, 537600
  buffer_load_dwordx4 v22, s[52:55], s8 offen lds
  s_waitcnt vmcnt(10)
  s_barrier
  s_add_u32 m0, s12, 0
  s_movk_i32 s8, 512
  buffer_load_dwordx4 v20, s[48:51], s8 offen lds
  s_add_u32 m0, s12, 1024
  s_movk_i32 s8, 7680
  buffer_load_dwordx4 v21, s[48:51], s8 offen lds
  s_add_u32 m0, s12, 2048
  s_movk_i32 s8, 14848
  buffer_load_dwordx4 v20, s[48:51], s8 offen lds
  s_add_u32 m0, s12, 3072
  s_movk_i32 s8, 22016
  buffer_load_dwordx4 v21, s[48:51], s8 offen lds
  s_add_u32 m0, s13, 16384
  s_mov_b32 s8, 689024
  buffer_load_dwordx4 v22, s[52:55], s8 offen lds
  s_add_u32 m0, s13, 17408
  s_mov_b32 s8, 710528
  buffer_load_dwordx4 v22, s[52:55], s8 offen lds
  s_add_u32 m0, s13, 24576
  s_mov_b32 s8, 689920
  buffer_load_dwordx4 v22, s[52:55], s8 offen lds
  s_add_u32 m0, s13, 25600
  s_mov_b32 s8, 711424
  buffer_load_dwordx4 v22, s[52:55], s8 offen lds
  s_add_u32 m0, s13, 32768
  s_mov_b32 s8, 688128
  buffer_load_dwordx4 v22, s[52:55], s8 offen lds
  s_add_u32 m0, s13, 33792
  s_mov_b32 s8, 709632
  buffer_load_dwordx4 v22, s[52:55], s8 offen lds
  s_waitcnt vmcnt(10)
  s_barrier
  s_add_u32 m0, s12, 40960
  s_movk_i32 s8, 640
  buffer_load_dwordx4 v20, s[48:51], s8 offen lds
  s_add_u32 m0, s12, 41984
  s_movk_i32 s8, 7808
  buffer_load_dwordx4 v21, s[48:51], s8 offen lds
  s_add_u32 m0, s12, 43008
  s_movk_i32 s8, 14976
  buffer_load_dwordx4 v20, s[48:51], s8 offen lds
  s_add_u32 m0, s12, 44032
  s_movk_i32 s8, 22144
  buffer_load_dwordx4 v21, s[48:51], s8 offen lds
  s_add_u32 m0, s13, 57344
  s_mov_b32 s8, 861056
  buffer_load_dwordx4 v22, s[52:55], s8 offen lds
  s_add_u32 m0, s13, 58368
  s_mov_b32 s8, 882560
  buffer_load_dwordx4 v22, s[52:55], s8 offen lds
  s_add_u32 m0, s13, 65536
  s_mov_b32 s8, 861952
  buffer_load_dwordx4 v22, s[52:55], s8 offen lds
  s_add_u32 m0, s13, 66560
  s_mov_b32 s8, 883456
  buffer_load_dwordx4 v22, s[52:55], s8 offen lds
  s_add_u32 m0, s13, 73728
  s_mov_b32 s8, 860160
  buffer_load_dwordx4 v22, s[52:55], s8 offen lds
  s_add_u32 m0, s13, 74752
  s_mov_b32 s8, 881664
  buffer_load_dwordx4 v22, s[52:55], s8 offen lds
  s_waitcnt vmcnt(10)
  s_barrier
  s_add_u32 m0, s12, 81920
  s_movk_i32 s8, 768
  buffer_load_dwordx4 v20, s[48:51], s8 offen lds
  s_add_u32 m0, s12, 82944
  s_movk_i32 s8, 7936
  buffer_load_dwordx4 v21, s[48:51], s8 offen lds
  s_add_u32 m0, s12, 83968
  s_movk_i32 s8, 15104
  buffer_load_dwordx4 v20, s[48:51], s8 offen lds
  s_add_u32 m0, s12, 84992
  s_movk_i32 s8, 22272
  buffer_load_dwordx4 v21, s[48:51], s8 offen lds
  s_add_u32 m0, s13, 98304
  s_mov_b32 s8, 1033088
  buffer_load_dwordx4 v22, s[52:55], s8 offen lds
  s_add_u32 m0, s13, 99328
  s_mov_b32 s8, 1054592
  buffer_load_dwordx4 v22, s[52:55], s8 offen lds
  s_add_u32 m0, s13, 106496
  s_mov_b32 s8, 1033984
  buffer_load_dwordx4 v22, s[52:55], s8 offen lds
  s_add_u32 m0, s13, 107520
  s_mov_b32 s8, 1055488
  buffer_load_dwordx4 v22, s[52:55], s8 offen lds
  s_add_u32 m0, s13, 114688
  s_mov_b32 s8, 1032192
  buffer_load_dwordx4 v22, s[52:55], s8 offen lds
  s_add_u32 m0, s13, 115712
  s_mov_b32 s8, 1053696
  buffer_load_dwordx4 v22, s[52:55], s8 offen lds
  s_waitcnt vmcnt(10)
  s_barrier
  global_load_dword v112, v30, s[42:43] sc1
  global_load_dword v113, v30, s[42:43] offset:128 sc1
  s_add_u32 s8, s5, 0
  s_and_b32 s8, s8, 7
  s_mul_i32 s8, s8, 25088
  s_add_u32 m0, s14, 122880
  s_nop 0
  buffer_load_dwordx4 v23, s[60:63], s8 offen lds
  s_add_u32 s8, s5, 1
  s_and_b32 s8, s8, 7
  s_mul_i32 s8, s8, 25088
  s_add_u32 m0, s14, 126976
  s_nop 0
  buffer_load_dwordx4 v23, s[60:63], s8 offen lds
  s_add_u32 s8, s5, 2
  s_and_b32 s8, s8, 7
  s_mul_i32 s8, s8, 25088
  s_add_u32 m0, s14, 131072
  s_nop 0
  buffer_load_dwordx4 v23, s[60:63], s8 offen lds
  s_add_u32 s8, s5, 3
  s_and_b32 s8, s8, 7
  s_mul_i32 s8, s8, 25088
  s_add_u32 m0, s14, 135168
  s_nop 0
  buffer_load_dwordx4 v23, s[60:63], s8 offen lds
  s_add_u32 s8, s5, 4
  s_and_b32 s8, s8, 7
  s_mul_i32 s8, s8, 25088
  s_add_u32 m0, s14, 139264
  s_nop 0
  buffer_load_dwordx4 v23, s[60:63], s8 offen lds
  s_add_u32 s8, s5, 5
  s_and_b32 s8, s8, 7
  s_mul_i32 s8, s8, 25088
  s_add_u32 m0, s14, 143360
  s_nop 0
  buffer_load_dwordx4 v23, s[60:63], s8 offen lds
  s_add_u32 s8, s5, 6
  s_and_b32 s8, s8, 7
  s_mul_i32 s8, s8, 25088
  s_add_u32 m0, s14, 147456
  s_nop 0
  buffer_load_dwordx4 v23, s[60:63], s8 offen lds
  s_add_u32 s8, s5, 7
  s_and_b32 s8, s8, 7
  s_mul_i32 s8, s8, 25088
  s_add_u32 m0, s14, 151552
  s_nop 0
  buffer_load_dwordx4 v23, s[60:63], s8 offen lds
  s_waitcnt vmcnt(10)
  s_barrier
  s_add_u32 s8, s5, 0
  s_and_b32 s8, s8, 7
  s_mul_i32 s8, s8, 25088
  s_add_u32 s8, s8, 200704
  s_add_u32 m0, s14, 0
  s_nop 0
  buffer_load_dwordx4 v23, s[60:63], s8 offen lds
  s_add_u32 s8, s5, 1
  s_and_b32 s8, s8, 7
  s_mul_i32 s8, s8, 25088
  s_add_u32 s8, s8, 200704
  s_add_u32 m0, s14, 4096
  s_nop 0
  buffer_load_dwordx4 v23, s[60:63], s8 offen lds
  s_add_u32 s8, s5, 2
  s_and_b32 s8, s8, 7
  s_mul_i32 s8, s8, 25088
  s_add_u32 s8, s8, 200704
  s_add_u32 m0, s14, 8192
  s_nop 0
  buffer_load_dwordx4 v23, s[60:63], s8 offen lds
  s_add_u32 s8, s5, 3
  s_and_b32 s8, s8, 7
  s_mul_i32 s8, s8, 25088
  s_add_u32 s8, s8, 200704
  s_add_u32 m0, s14, 12288
  s_nop 0
  buffer_load_dwordx4 v23, s[60:63], s8 offen lds
  s_add_u32 s8, s5, 4
  s_and_b32 s8, s8, 7
  s_mul_i32 s8, s8, 25088
  s_add_u32 s8, s8, 200704
  s_add_u32 m0, s14, 16384
  s_nop 0
  buffer_load_dwordx4 v23, s[60:63], s8 offen lds
  s_add_u32 s8, s5, 5
  s_and_b32 s8, s8, 7
  s_mul_i32 s8, s8, 25088
  s_add_u32 s8, s8, 200704
  s_add_u32 m0, s14, 20480
  s_nop 0
  buffer_load_dwordx4 v23, s[60:63], s8 offen lds
  s_add_u32 s8, s5, 6
  s_and_b32 s8, s8, 7
  s_mul_i32 s8, s8, 25088
  s_add_u32 s8, s8, 200704
  s_add_u32 m0, s14, 24576
  s_nop 0
  buffer_load_dwordx4 v23, s[60:63], s8 offen lds
  s_add_u32 s8, s5, 7
  s_and_b32 s8, s8, 7
  s_mul_i32 s8, s8, 25088
  s_add_u32 s8, s8, 200704
  s_add_u32 m0, s14, 28672
  s_nop 0
  buffer_load_dwordx4 v23, s[60:63], s8 offen lds
  s_barrier
  s_mov_b32 s46, 1069066811
  s_mov_b32 s47, 1069066811
  s_mov_b32 s68, 1.0
  s_mov_b32 s69, 1.0
  s_mov_b32 s72, 897988541
  s_mov_b32 s73, 897988541
  s_lshl_b32 s8, s6, 12
  s_add_u32 s8, s8, 40960
  v_lshl_add_u32 v10, v1, 4, s8
  v_lshlrev_b32 v11, 4, v1
  s_lshl_b32 s14, s4, 2
  s_and_b32 s9, s6, 1
  s_lshl_b32 s9, s9, 1
  s_add_u32 s14, s14, s9
  s_lshl_b32 s14, s14, 4
  s_lshl_b32 s9, s5, 1
  s_add_u32 s14, s14, s9
  s_lshr_b32 s9, s6, 1
  s_add_u32 s14, s14, s9
  s_lshl_b32 s14, s14, 11
  s_add_u32 s14, s14, 2097152
  s_add_u32 s15, s14, 32768
  v_cmp_eq_u32 vcc, 0, v3
  v_mov_b32 v18, 35840
  s_waitcnt vmcnt(16)
  v_readfirstlane_b32 s74, v112
  v_readfirstlane_b32 s75, v113
  s_mov_b32 s9, 0
Lnn_8:
  s_cmp_eq_u32 s74, 0
  s_cselect_b32 s75, 0, s75
  s_cmp_ge_u32 s75, 16
  s_cbranch_scc1 Lnd_9
  global_load_dword v112, v30, s[42:43] sc1
  global_load_dword v113, v30, s[42:43] offset:128 sc1
  s_add_u32 s9, s9, 1
  s_waitcnt vmcnt(0)
  v_readfirstlane_b32 s74, v112
  v_readfirstlane_b32 s75, v113
  s_cmp_lt_u32 s9, 200000
  s_cbranch_scc1 Lnn_8
Lnd_9:
  s_cmp_lg_u32 s3, 7
  s_cbranch_scc1 Lci_10
  v_mov_b32 v26, s74
  v_mov_b32 v27, 0
  v_mov_b32 v28, 0
  v_mov_b32 v29, 0
  ds_write_b128 v18, v[26:29]
  v_mov_b32 v26, 0
  ds_write_b128 v18, v[26:29] offset:16
  ds_write_b128 v18, v[26:29] offset:32
  s_waitcnt lgkmcnt(0)
Lci_10:
  s_barrier
  s_setprio 2
  ds_read_b128 v[48:51], v10 offset:0
  ds_read_b128 v[52:55], v10 offset:1024
  ds_read_b128 v[56:59], v10 offset:2048
  ds_read_b128 v[60:63], v10 offset:3072
  s_waitcnt lgkmcnt(3)
  v_lshlrev_b32 v64, 16, v48
  v_and_b32 v65, 0xffff0000, v48
  v_lshlrev_b32 v66, 16, v49
  v_and_b32 v67, 0xffff0000, v49
  v_lshlrev_b32 v68, 16, v50
  v_and_b32 v69, 0xffff0000, v50
  v_lshlrev_b32 v70, 16, v51
  v_and_b32 v71, 0xffff0000, v51
  s_waitcnt lgkmcnt(2)
  v_lshlrev_b32 v72, 16, v52
  v_and_b32 v73, 0xffff0000, v52
  v_lshlrev_b32 v74, 16, v53
  v_and_b32 v75, 0xffff0000, v53
  v_lshlrev_b32 v76, 16, v54
  v_and_b32 v77, 0xffff0000, v54
  v_lshlrev_b32 v78, 16, v55
  v_and_b32 v79, 0xffff0000, v55
  s_waitcnt lgkmcnt(1)
  v_lshlrev_b32 v80, 16, v56
  v_and_b32 v81, 0xffff0000, v56
  v_lshlrev_b32 v82, 16, v57
  v_and_b32 v83, 0xffff0000, v57
  v_lshlrev_b32 v84, 16, v58
  v_and_b32 v85, 0xffff0000, v58
  v_lshlrev_b32 v86, 16, v59
  v_and_b32 v87, 0xffff0000, v59
  s_waitcnt lgkmcnt(0)
  v_lshlrev_b32 v88, 16, v60
  v_and_b32 v89, 0xffff0000, v60
  v_lshlrev_b32 v90, 16, v61
  v_and_b32 v91, 0xffff0000, v61
  v_lshlrev_b32 v92, 16, v62
  v_and_b32 v93, 0xffff0000, v62
  v_lshlrev_b32 v94, 16, v63
  v_and_b32 v95, 0xffff0000, v63
  v_pk_mul_f32 v[96:97], v[64:65], s[46:47]
  v_pk_mul_f32 v[98:99], v[66:67], s[46:47]
  v_pk_mul_f32 v[100:101], v[68:69], s[46:47]
  v_pk_mul_f32 v[102:103], v[70:71], s[46:47]
  v_pk_mul_f32 v[104:105], v[72:73], s[46:47]
  v_pk_mul_f32 v[106:107], v[74:75], s[46:47]
  v_pk_mul_f32 v[108:109], v[76:77], s[46:47]
  v_pk_mul_f32 v[110:111], v[78:79], s[46:47]
  v_pk_mul_f32 v[112:113], v[80:81], s[46:47]
  v_pk_mul_f32 v[114:115], v[82:83], s[46:47]
  v_pk_mul_f32 v[116:117], v[84:85], s[46:47]
  v_pk_mul_f32 v[118:119], v[86:87], s[46:47]
  v_pk_mul_f32 v[120:121], v[88:89], s[46:47]
  v_pk_mul_f32 v[122:123], v[90:91], s[46:47]
  v_pk_mul_f32 v[124:125], v[92:93], s[46:47]
  v_pk_mul_f32 v[126:127], v[94:95], s[46:47]
  v_exp_f32 v96, v96 clamp
  v_exp_f32 v97, v97 clamp
  v_pk_add_f32 v[64:65], v[64:65], s[68:69]
  v_exp_f32 v98, v98 clamp
  v_exp_f32 v99, v99 clamp
  v_pk_add_f32 v[66:67], v[66:67], s[68:69]
  v_exp_f32 v100, v100 clamp
  v_exp_f32 v101, v101 clamp
  v_pk_add_f32 v[68:69], v[68:69], s[68:69]
  v_exp_f32 v102, v102 clamp
  v_exp_f32 v103, v103 clamp
  v_pk_add_f32 v[70:71], v[70:71], s[68:69]
  v_exp_f32 v104, v104 clamp
  v_exp_f32 v105, v105 clamp
  v_pk_add_f32 v[72:73], v[72:73], s[68:69]
  v_exp_f32 v106, v106 clamp
  v_exp_f32 v107, v107 clamp
  v_pk_add_f32 v[74:75], v[74:75], s[68:69]
  v_exp_f32 v108, v108 clamp
  v_exp_f32 v109, v109 clamp
  v_pk_add_f32 v[76:77], v[76:77], s[68:69]
  v_exp_f32 v110, v110 clamp
  v_exp_f32 v111, v111 clamp
  v_pk_add_f32 v[78:79], v[78:79], s[68:69]
  v_exp_f32 v112, v112 clamp
  v_exp_f32 v113, v113 clamp
  v_pk_add_f32 v[80:81], v[80:81], s[68:69]
  v_exp_f32 v114, v114 clamp
  v_exp_f32 v115, v115 clamp
  v_pk_add_f32 v[82:83], v[82:83], s[68:69]
  v_exp_f32 v116, v116 clamp
  v_exp_f32 v117, v117 clamp
  v_pk_add_f32 v[84:85], v[84:85], s[68:69]
  v_exp_f32 v118, v118 clamp
  v_exp_f32 v119, v119 clamp
  v_pk_add_f32 v[86:87], v[86:87], s[68:69]
  v_exp_f32 v120, v120 clamp
  v_exp_f32 v121, v121 clamp
  v_pk_add_f32 v[88:89], v[88:89], s[68:69]
  v_exp_f32 v122, v122 clamp
  v_exp_f32 v123, v123 clamp
  v_pk_add_f32 v[90:91], v[90:91], s[68:69]
  v_exp_f32 v124, v124 clamp
  v_exp_f32 v125, v125 clamp
  v_pk_add_f32 v[92:93], v[92:93], s[68:69]
  v_exp_f32 v126, v126 clamp
  v_exp_f32 v127, v127 clamp
  v_pk_add_f32 v[94:95], v[94:95], s[68:69]
  v_max_f32 v96, v96, v64
  v_max_f32 v97, v97, v65
  v_pk_add_f32 v[96:97], v[96:97], s[72:73]
  v_max_f32 v98, v98, v66
  v_max_f32 v99, v99, v67
  v_pk_add_f32 v[98:99], v[98:99], s[72:73]
  v_max_f32 v100, v100, v68
  v_max_f32 v101, v101, v69
  v_pk_add_f32 v[100:101], v[100:101], s[72:73]
  v_max_f32 v102, v102, v70
  v_max_f32 v103, v103, v71
  v_pk_add_f32 v[102:103], v[102:103], s[72:73]
  v_max_f32 v104, v104, v72
  v_max_f32 v105, v105, v73
  v_pk_add_f32 v[104:105], v[104:105], s[72:73]
  v_max_f32 v106, v106, v74
  v_max_f32 v107, v107, v75
  v_pk_add_f32 v[106:107], v[106:107], s[72:73]
  v_max_f32 v108, v108, v76
  v_max_f32 v109, v109, v77
  v_pk_add_f32 v[108:109], v[108:109], s[72:73]
  v_max_f32 v110, v110, v78
  v_max_f32 v111, v111, v79
  v_pk_add_f32 v[110:111], v[110:111], s[72:73]
  v_max_f32 v112, v112, v80
  v_max_f32 v113, v113, v81
  v_pk_add_f32 v[112:113], v[112:113], s[72:73]
  v_max_f32 v114, v114, v82
  v_max_f32 v115, v115, v83
  v_pk_add_f32 v[114:115], v[114:115], s[72:73]
  v_max_f32 v116, v116, v84
  v_max_f32 v117, v117, v85
  v_pk_add_f32 v[116:117], v[116:117], s[72:73]
  v_max_f32 v118, v118, v86
  v_max_f32 v119, v119, v87
  v_pk_add_f32 v[118:119], v[118:119], s[72:73]
  v_max_f32 v120, v120, v88
  v_max_f32 v121, v121, v89
  v_pk_add_f32 v[120:121], v[120:121], s[72:73]
  v_max_f32 v122, v122, v90
  v_max_f32 v123, v123, v91
  v_pk_add_f32 v[122:123], v[122:123], s[72:73]
  v_max_f32 v124, v124, v92
  v_max_f32 v125, v125, v93
  v_pk_add_f32 v[124:125], v[124:125], s[72:73]
  v_max_f32 v126, v126, v94
  v_max_f32 v127, v127, v95
  v_pk_add_f32 v[126:127], v[126:127], s[72:73]
  v_cvt_pk_bf16_f32 v128, v96, v97
  v_cvt_pk_bf16_f32 v129, v98, v99
  v_cvt_pk_bf16_f32 v130, v100, v101
  v_cvt_pk_bf16_f32 v131, v102, v103
  v_cvt_pk_bf16_f32 v132, v104, v105
  v_cvt_pk_bf16_f32 v133, v106, v107
  v_cvt_pk_bf16_f32 v134, v108, v109
  v_cvt_pk_bf16_f32 v135, v110, v111
  v_cvt_pk_bf16_f32 v136, v112, v113
  v_cvt_pk_bf16_f32 v137, v114, v115
  v_cvt_pk_bf16_f32 v138, v116, v117
  v_cvt_pk_bf16_f32 v139, v118, v119
  v_cvt_pk_bf16_f32 v140, v120, v121
  v_cvt_pk_bf16_f32 v141, v122, v123
  v_cvt_pk_bf16_f32 v142, v124, v125
  v_cvt_pk_bf16_f32 v143, v126, v127
  v_cndmask_b32 v134, 0, v134, vcc
  v_cndmask_b32 v135, 0, v135, vcc
  v_cndmask_b32 v142, 0, v142, vcc
  v_cndmask_b32 v143, 0, v143, vcc
  buffer_store_dwordx4 v[128:131], v11, s[56:59], s14 offen sc0 sc1
  buffer_store_dwordx4 v[132:135], v11, s[56:59], s14 offen offset:1024 sc0 sc1
  buffer_store_dwordx4 v[136:139], v11, s[56:59], s15 offen sc0 sc1
  buffer_store_dwordx4 v[140:143], v11, s[56:59], s15 offen offset:1024 sc0 sc1
  s_setprio 0
  v_mov_b32 v19, s74
  s_lshl_b32 s8, s4, 3
  s_add_u32 s8, s8, s5
  s_lshl_b32 s8, s8, 7
  s_add_u32 s9, s8, 4358144
  v_mov_b32 v26, 1
  s_waitcnt vmcnt(0)
  s_mov_b64 exec, 1
  ds_add_rtn_u32 v27, v18, v26 offset:8
  s_waitcnt lgkmcnt(0)
  v_readfirstlane_b32 s10, v27
  s_nop 0
  s_cmp_lg_u32 s10, 3
  s_cbranch_scc1 Lfl_11
  buffer_store_dword v19, v30, s[56:59], s9 offen sc0 sc1
  ds_write_b32 v18, v19 offset:16
Lfl_11:
  s_mov_b64 exec, -1
Lb2_2:
  v_lshrrev_b32 v8, 3, v1
  v_and_b32 v9, 7, v1
  v_lshrrev_b32 v10, 4, v1
  v_xor_b32 v10, v9, v10
  v_and_b32 v9, 3, v8
  s_lshl_b32 s8, s6, 2
  v_add_u32 v9, s8, v9
  v_mad_u32_u24 v12, v3, 14, v9
  v_cmp_gt_u32 vcc, 14, v9
  s_nop 1
  v_cndmask_b32 v12, 28, v12, vcc
  v_lshlrev_b32 v12, 7, v12
  v_lshl_add_u32 v13, v10, 4, v12
  v_mov_b32 v9, v2
  v_bfe_u32 v8, v9, 1, 3
  v_xor_b32 v8, v8, v3
  s_lshl_b32 s8, s7, 15
  s_add_u32 s8, s8, 40960
  v_lshl_add_u32 v9, v9, 7, s8
  v_xor_b32 v10, 0, v8
  v_lshl_add_u32 v20, v10, 4, v9
  v_xor_b32 v10, 2, v8
  v_lshl_add_u32 v21, v10, 4, v9
  v_xor_b32 v10, 4, v8
  v_lshl_add_u32 v22, v10, 4, v9
  v_xor_b32 v10, 6, v8
  v_lshl_add_u32 v23, v10, 4, v9
  v_mad_u32_u24 v8, v3, 14, v4
  v_lshlrev_b32 v9, 6, v3
  v_xor_b32 v9, v9, v6
  v_xor_b32 v9, v7, v9
  v_lshl_add_u32 v8, v8, 7, v9
  s_cmp_eq_u32 s7, 0
  s_cselect_b32 s8, 122880, 0
  v_add_u32 v24, s8, v8
  s_lshl_b32 s8, s7, 6
  v_xor_b32 v24, s8, v24
  v_xor_b32 v25, 64, v24
  v_mov_b32 v48, 0
  v_mov_b32 v49, 0
  v_mov_b32 v50, 0
  v_mov_b32 v51, 0
  v_mov_b32 v52, 0
  v_mov_b32 v53, 0
  v_mov_b32 v54, 0
  v_mov_b32 v55, 0
  v_mov_b32 v56, 0
  v_mov_b32 v57, 0
  v_mov_b32 v58, 0
  v_mov_b32 v59, 0
  v_mov_b32 v60, 0
  v_mov_b32 v61, 0
  v_mov_b32 v62, 0
  v_mov_b32 v63, 0
  v_mov_b32 v64, 0
  v_mov_b32 v65, 0
  v_mov_b32 v66, 0
  v_mov_b32 v67, 0
  v_mov_b32 v68, 0
  v_mov_b32 v69, 0
  v_mov_b32 v70, 0
  v_mov_b32 v71, 0
  v_mov_b32 v72, 0
  v_mov_b32 v73, 0
  v_mov_b32 v74, 0
  v_mov_b32 v75, 0
  v_mov_b32 v76, 0
  v_mov_b32 v77, 0
  v_mov_b32 v78, 0
  v_mov_b32 v79, 0
  v_mov_b32 v47, 0
  v_mov_b32 v231, 0
  v_lshlrev_b32 v12, 4, v1
  v_lshlrev_b32 v15, 7, v1
  v_add_u32 v16, 8192, v15
  v_and_b32 v17, 7, v1
  v_lshlrev_b32 v17, 7, v17
  s_lshl_b32 s8, s4, 10
  v_add_u32 v17, s8, v17
  v_mov_b32 v18, 35840
  ds_read_b32 v19, v18
  s_waitcnt lgkmcnt(0)
  v_readfirstlane_b32 s74, v19
  s_cmp_ge_u32 s5, 7
  s_cbranch_scc1 L_end_concat_heads__ssm_conv_s4__linear_attn_block__prompt_kernel
  s_mov_b32 s10, 4325376
  s_lshl_b32 s8, s4, 2
  s_add_u32 s8, s8, s6
  s_lshl_b32 s8, s8, 15
  s_lshl_b32 s9, s7, 14
  s_add_u32 s8, s8, s9
  s_add_u32 s8, s8, 2097152
  s_and_b32 s9, s3, 1
  s_lshl_b32 s9, s9, 6
  v_xor_b32 v13, s9, v13
  s_lshl_b32 s11, s7, 15
  s_lshl_b32 s9, s6, 10
  s_add_u32 s9, s9, s11
  s_add_u32 s11, s11, 4194304
  s_cmp_eq_u32 s3, 4
  s_cbranch_scc1 Lgp_12
  s_mov_b32 s13, 0
Lsp_14:
  ds_read_b32 v26, v18 offset:4
  s_add_u32 s13, s13, 1
  s_waitcnt lgkmcnt(0)
  v_readfirstlane_b32 s12, v26
  s_cmp_ge_u32 s13, 1600000
  s_cselect_b32 s12, s74, s12
  s_cmp_lg_u32 s12, s74
  s_cbranch_scc1 Lsp_14
  s_add_u32 s12, s5, 0
  s_and_b32 s12, s12, 7
  s_lshl_b32 s12, s12, 11
  s_add_u32 s12, s12, s8
  buffer_load_dwordx4 v[128:131], v12, s[56:59], s12 offen offset:0 sc1
  buffer_load_dwordx4 v[132:135], v12, s[56:59], s12 offen offset:1024 sc1
  s_add_u32 s12, s5, 1
  s_and_b32 s12, s12, 7
  s_lshl_b32 s12, s12, 11
  s_add_u32 s12, s12, s8
  buffer_load_dwordx4 v[136:139], v12, s[56:59], s12 offen offset:0 sc1
  buffer_load_dwordx4 v[140:143], v12, s[56:59], s12 offen offset:1024 sc1
  s_add_u32 s12, s5, 2
  s_and_b32 s12, s12, 7
  s_lshl_b32 s12, s12, 11
  s_add_u32 s12, s12, s8
  buffer_load_dwordx4 v[144:147], v12, s[56:59], s12 offen offset:0 sc1
  buffer_load_dwordx4 v[148:151], v12, s[56:59], s12 offen offset:1024 sc1
  s_add_u32 s12, s5, 3
  s_and_b32 s12, s12, 7
  s_lshl_b32 s12, s12, 11
  s_add_u32 s12, s12, s8
  s_waitcnt vmcnt(5)
  buffer_load_dwordx4 v[152:155], v12, s[56:59], s12 offen offset:0 sc1
  s_waitcnt vmcnt(5)
  buffer_load_dwordx4 v[156:159], v12, s[56:59], s12 offen offset:1024 sc1
  s_add_u32 s12, s5, 4
  s_and_b32 s12, s12, 7
  s_lshl_b32 s12, s12, 11
  s_add_u32 s12, s12, s8
  s_waitcnt vmcnt(5)
  buffer_load_dwordx4 v[160:163], v12, s[56:59], s12 offen offset:0 sc1
  s_waitcnt vmcnt(5)
  buffer_load_dwordx4 v[164:167], v12, s[56:59], s12 offen offset:1024 sc1
  s_add_u32 s12, s5, 5
  s_and_b32 s12, s12, 7
  s_lshl_b32 s12, s12, 11
  s_add_u32 s12, s12, s8
  s_waitcnt vmcnt(5)
  buffer_load_dwordx4 v[168:171], v12, s[56:59], s12 offen offset:0 sc1
  s_waitcnt vmcnt(5)
  buffer_load_dwordx4 v[172:175], v12, s[56:59], s12 offen offset:1024 sc1
  s_add_u32 s12, s5, 6
  s_and_b32 s12, s12, 7
  s_lshl_b32 s12, s12, 11
  s_add_u32 s12, s12, s8
  s_waitcnt vmcnt(5)
  buffer_load_dwordx4 v[176:179], v12, s[56:59], s12 offen offset:0 sc1
  s_waitcnt vmcnt(5)
  buffer_load_dwordx4 v[180:183], v12, s[56:59], s12 offen offset:1024 sc1
  s_add_u32 s12, s5, 7
  s_and_b32 s12, s12, 7
  s_lshl_b32 s12, s12, 11
  s_add_u32 s12, s12, s8
  s_waitcnt vmcnt(5)
  buffer_load_dwordx4 v[184:187], v12, s[56:59], s12 offen offset:0 sc1
  s_waitcnt vmcnt(5)
  buffer_load_dwordx4 v[188:191], v12, s[56:59], s12 offen offset:1024 sc1
  s_branch Lgq_13
Lgp_12:
  s_mov_b32 s13, 0
Lsp_15:
  ds_read_b32 v26, v18 offset:16
  s_add_u32 s13, s13, 1
  s_waitcnt lgkmcnt(0)
  v_readfirstlane_b32 s12, v26
  s_cmp_ge_u32 s13, 1600000
  s_cselect_b32 s12, s74, s12
  s_cmp_lg_u32 s12, s74
  s_cbranch_scc1 Lsp_15
  s_mov_b32 s10, 4358144
  s_mov_b32 s13, 0
Lpl_16:
  buffer_load_dword v26, v17, s[56:59], s10 offen sc1
  s_waitcnt vmcnt(0)
  v_cmp_ne_u32 vcc, s74, v26
  s_add_u32 s13, s13, 1
  s_cmp_eq_u64 vcc, 0
  s_cbranch_scc1 Lpd_17
  s_cmp_lt_u32 s13, 200000
  s_cbranch_scc1 Lpl_16
Lpd_17:
  ds_write_b32 v18, v19 offset:4
  s_add_u32 s12, s5, 0
  s_and_b32 s12, s12, 7
  s_lshl_b32 s12, s12, 11
  s_add_u32 s12, s12, s8
  buffer_load_dwordx4 v[128:131], v12, s[56:59], s12 offen offset:0 sc1
  buffer_load_dwordx4 v[132:135], v12, s[56:59], s12 offen offset:1024 sc1
  s_add_u32 s12, s5, 1
  s_and_b32 s12, s12, 7
  s_lshl_b32 s12, s12, 11
  s_add_u32 s12, s12, s8
  buffer_load_dwordx4 v[136:139], v12, s[56:59], s12 offen offset:0 sc1
  buffer_load_dwordx4 v[140:143], v12, s[56:59], s12 offen offset:1024 sc1
  s_add_u32 s12, s5, 2
  s_and_b32 s12, s12, 7
  s_lshl_b32 s12, s12, 11
  s_add_u32 s12, s12, s8
  buffer_load_dwordx4 v[144:147], v12, s[56:59], s12 offen offset:0 sc1
  buffer_load_dwordx4 v[148:151], v12, s[56:59], s12 offen offset:1024 sc1
  s_add_u32 s12, s5, 3
  s_and_b32 s12, s12, 7
  s_lshl_b32 s12, s12, 11
  s_add_u32 s12, s12, s8
  s_waitcnt vmcnt(5)
  buffer_load_dwordx4 v[152:155], v12, s[56:59], s12 offen offset:0 sc1
  s_waitcnt vmcnt(5)
  buffer_load_dwordx4 v[156:159], v12, s[56:59], s12 offen offset:1024 sc1
  s_add_u32 s12, s5, 4
  s_and_b32 s12, s12, 7
  s_lshl_b32 s12, s12, 11
  s_add_u32 s12, s12, s8
  s_waitcnt vmcnt(5)
  buffer_load_dwordx4 v[160:163], v12, s[56:59], s12 offen offset:0 sc1
  s_waitcnt vmcnt(5)
  buffer_load_dwordx4 v[164:167], v12, s[56:59], s12 offen offset:1024 sc1
  s_add_u32 s12, s5, 5
  s_and_b32 s12, s12, 7
  s_lshl_b32 s12, s12, 11
  s_add_u32 s12, s12, s8
  s_waitcnt vmcnt(5)
  buffer_load_dwordx4 v[168:171], v12, s[56:59], s12 offen offset:0 sc1
  s_waitcnt vmcnt(5)
  buffer_load_dwordx4 v[172:175], v12, s[56:59], s12 offen offset:1024 sc1
  s_add_u32 s12, s5, 6
  s_and_b32 s12, s12, 7
  s_lshl_b32 s12, s12, 11
  s_add_u32 s12, s12, s8
  s_waitcnt vmcnt(5)
  buffer_load_dwordx4 v[176:179], v12, s[56:59], s12 offen offset:0 sc1
  s_waitcnt vmcnt(5)
  buffer_load_dwordx4 v[180:183], v12, s[56:59], s12 offen offset:1024 sc1
  s_add_u32 s12, s5, 7
  s_and_b32 s12, s12, 7
  s_lshl_b32 s12, s12, 11
  s_add_u32 s12, s12, s8
  s_waitcnt vmcnt(5)
  buffer_load_dwordx4 v[184:187], v12, s[56:59], s12 offen offset:0 sc1
  s_waitcnt vmcnt(5)
  buffer_load_dwordx4 v[188:191], v12, s[56:59], s12 offen offset:1024 sc1
  s_mov_b32 s10, 4325376
  s_mov_b32 s13, 0
Lpl_18:
  buffer_load_dword v26, v15, s[56:59], s10 offen sc1
  buffer_load_dword v27, v16, s[56:59], s10 offen sc1
  s_waitcnt vmcnt(0)
  v_cmp_ne_u32 vcc, s74, v26
  s_nop 0
  s_mov_b64 s[70:71], vcc
  v_cmp_ne_u32 vcc, s74, v27
  s_nop 0
  s_or_b64 vcc, vcc, s[70:71]
  s_add_u32 s13, s13, 1
  s_cmp_eq_u64 vcc, 0
  s_cbranch_scc1 Lpd_19
  s_cmp_lt_u32 s13, 200000
  s_cbranch_scc1 Lpl_18
Lpd_19:
Lgq_13:
  s_barrier
  s_add_u32 s10, s5, 0
  s_and_b32 s10, s10, 7
  s_lshl_b32 s10, s10, 12
  s_add_u32 s10, s10, s11
  s_add_u32 m0, s9, 40960
  s_nop 0
  buffer_load_dwordx4 v13, s[56:59], s10 offen sc1 lds
  s_add_u32 s10, s5, 1
  s_and_b32 s10, s10, 7
  s_lshl_b32 s10, s10, 12
  s_add_u32 s10, s10, s11
  s_add_u32 m0, s9, 45056
  s_nop 0
  buffer_load_dwordx4 v13, s[56:59], s10 offen sc1 lds
  s_add_u32 s10, s5, 2
  s_and_b32 s10, s10, 7
  s_lshl_b32 s10, s10, 12
  s_add_u32 s10, s10, s11
  s_add_u32 m0, s9, 49152
  s_nop 0
  buffer_load_dwordx4 v13, s[56:59], s10 offen sc1 lds
  s_add_u32 s10, s5, 3
  s_and_b32 s10, s10, 7
  s_lshl_b32 s10, s10, 12
  s_add_u32 s10, s10, s11
  s_add_u32 m0, s9, 53248
  s_nop 0
  buffer_load_dwordx4 v13, s[56:59], s10 offen sc1 lds
  s_add_u32 s10, s5, 4
  s_and_b32 s10, s10, 7
  s_lshl_b32 s10, s10, 12
  s_add_u32 s10, s10, s11
  s_add_u32 m0, s9, 57344
  s_nop 0
  buffer_load_dwordx4 v13, s[56:59], s10 offen sc1 lds
  s_add_u32 s10, s5, 5
  s_and_b32 s10, s10, 7
  s_lshl_b32 s10, s10, 12
  s_add_u32 s10, s10, s11
  s_add_u32 m0, s9, 61440
  s_nop 0
  buffer_load_dwordx4 v13, s[56:59], s10 offen sc1 lds
  s_add_u32 s10, s5, 6
  s_and_b32 s10, s10, 7
  s_lshl_b32 s10, s10, 12
  s_add_u32 s10, s10, s11
  s_add_u32 m0, s9, 65536
  s_nop 0
  buffer_load_dwordx4 v13, s[56:59], s10 offen sc1 lds
  s_add_u32 s10, s5, 7
  s_and_b32 s10, s10, 7
  s_lshl_b32 s10, s10, 12
  s_add_u32 s10, s10, s11
  s_add_u32 m0, s9, 69632
  s_nop 0
  buffer_load_dwordx4 v13, s[56:59], s10 offen sc1 lds
  s_lshl_b32 s14, s3, 12
  s_mov_b32 s8, 98304
  s_cmp_lt_u32 s3, 2
  s_cselect_b32 s8, 32768, s8
  s_cmp_ge_u32 s3, 6
  s_cselect_b32 s8, 131072, s8
  s_add_u32 s14, s14, s8
  s_xor_b32 s9, s3, 4
  s_lshl_b32 s15, s9, 12
  s_mov_b32 s8, 98304
  s_cmp_lt_u32 s9, 2
  s_cselect_b32 s8, 32768, s8
  s_cmp_ge_u32 s9, 6
  s_cselect_b32 s8, 131072, s8
  s_add_u32 s15, s15, s8
  v_lshl_add_u32 v26, v1, 4, s14
  v_lshl_add_u32 v27, v1, 4, s15
  v_lshrrev_b32 v8, 2, v1
  v_and_b32 v9, 3, v1
  v_mul_u32_u24 v28, 1792, v8
  v_lshl_add_u32 v28, v9, 4, v28
  v_bfe_u32 v10, v1, 3, 2
  v_xor_b32 v9, v9, v10
  v_lshlrev_b32 v8, 6, v8
  v_lshl_add_u32 v8, v9, 4, v8
  v_add_u32 v29, s15, v8
  v_bfe_u32 v10, v2, 1, 2
  v_lshlrev_b32 v9, 6, v2
  v_lshl_add_u32 v9, v3, 3, v9
  v_add_u32 v9, s15, v9
  v_xor_b32 v8, 0, v10
  v_lshl_add_u32 v14, v8, 4, v9
  v_xor_b32 v8, 1, v10
  v_lshl_add_u32 v15, v8, 4, v9
  v_xor_b32 v8, 2, v10
  v_lshl_add_u32 v16, v8, 4, v9
  v_xor_b32 v8, 3, v10
  v_lshl_add_u32 v17, v8, 4, v9
  s_lshl_b32 s8, s4, 2
  s_add_u32 s8, s8, s6
  s_mul_i32 s8, s8, 57344
  s_lshl_b32 s9, s5, 7
  s_add_u32 s8, s8, s9
  s_lshl_b32 s9, s7, 6
  s_add_u32 s8, s8, s9
  s_add_u32 s46, s8, 896
  s_add_u32 s47, s46, 28672
  s_waitcnt vmcnt(5)
  s_barrier
  ds_read_b128 v[112:115], v20 offset:0
  ds_read_b128 v[116:119], v21 offset:0
  ds_read_b128 v[120:123], v22 offset:0
  ds_read_b128 v[124:127], v23 offset:0
  ds_read_b128 v[232:235], v20 offset:4096
  ds_read_b128 v[236:239], v21 offset:4096
  ds_read_b128 v[240:243], v22 offset:4096
  ds_read_b128 v[244:247], v23 offset:4096
  s_waitcnt lgkmcnt(4)
  v_cvt_pk_bf16_f32 v32, v112, v113
  v_cvt_pk_bf16_f32 v33, v114, v115
  v_cvt_pk_bf16_f32 v34, v116, v117
  v_cvt_pk_bf16_f32 v35, v118, v119
  v_cvt_pk_bf16_f32 v36, v120, v121
  v_cvt_pk_bf16_f32 v37, v122, v123
  v_cvt_pk_bf16_f32 v38, v124, v125
  v_cvt_pk_bf16_f32 v39, v126, v127
  ds_read_b128 v[112:115], v20 offset:8192
  ds_read_b128 v[116:119], v21 offset:8192
  ds_read_b128 v[120:123], v22 offset:8192
  ds_read_b128 v[124:127], v23 offset:8192
  v_mfma_f32_32x32x16_bf16 v[80:95], v[32:35], v[128:131], 0
  v_mfma_f32_32x32x16_bf16 v[80:95], v[36:39], v[132:135], v[80:95]
  s_waitcnt lgkmcnt(4)
  v_cvt_pk_bf16_f32 v32, v232, v233
  v_cvt_pk_bf16_f32 v33, v234, v235
  v_cvt_pk_bf16_f32 v34, v236, v237
  v_cvt_pk_bf16_f32 v35, v238, v239
  v_cvt_pk_bf16_f32 v36, v240, v241
  v_cvt_pk_bf16_f32 v37, v242, v243
  v_cvt_pk_bf16_f32 v38, v244, v245
  v_cvt_pk_bf16_f32 v39, v246, v247
  v_mfma_f32_32x32x16_bf16 v[96:111], v[32:35], v[136:139], 0
  s_waitcnt vmcnt(0)
  s_barrier
  ds_read_b128 v[232:235], v20 offset:12288
  ds_read_b128 v[236:239], v21 offset:12288
  ds_read_b128 v[240:243], v22 offset:12288
  ds_read_b128 v[244:247], v23 offset:12288
  v_add_f32 v9, 897988541, v94
  v_rcp_f32 v10, v9
  s_nop 0
  v_mul_f32 v80, v10, v80
  v_mul_f32 v81, v10, v81
  v_mul_f32 v82, v10, v82
  v_mul_f32 v83, v10, v83
  v_cvt_pk_bf16_f32 v40, v80, v81
  v_mul_f32 v84, v10, v84
  v_mul_f32 v85, v10, v85
  v_cvt_pk_bf16_f32 v41, v82, v83
  v_mul_f32 v86, v10, v86
  v_mul_f32 v87, v10, v87
  v_cvt_pk_bf16_f32 v42, v84, v85
  v_mul_f32 v88, v10, v88
  v_mul_f32 v89, v10, v89
  v_cvt_pk_bf16_f32 v43, v86, v87
  v_mfma_f32_32x32x16_bf16 v[96:111], v[36:39], v[140:143], v[96:111]
  ds_read_b64_tr_b16 v[192:193], v24 offset:0
  ds_read_b64_tr_b16 v[194:195], v24 offset:512
  v_mul_f32 v90, v10, v90
  v_mul_f32 v91, v10, v91
  v_cvt_pk_bf16_f32 v44, v88, v89
  v_mul_f32 v92, v10, v92
  v_mul_f32 v93, v10, v93
  v_cvt_pk_bf16_f32 v45, v90, v91
  v_cvt_pk_bf16_f32 v46, v92, v93
  s_waitcnt lgkmcnt(6)
  v_cvt_pk_bf16_f32 v32, v112, v113
  v_cvt_pk_bf16_f32 v33, v114, v115
  v_cvt_pk_bf16_f32 v34, v116, v117
  v_cvt_pk_bf16_f32 v35, v118, v119
  v_cvt_pk_bf16_f32 v36, v120, v121
  v_cvt_pk_bf16_f32 v37, v122, v123
  v_cvt_pk_bf16_f32 v38, v124, v125
  v_cvt_pk_bf16_f32 v39, v126, v127
  ds_read_b64_tr_b16 v[196:197], v25 offset:0
  ds_read_b64_tr_b16 v[198:199], v25 offset:512
  ds_read_b64_tr_b16 v[200:201], v24 offset:1024
  ds_read_b64_tr_b16 v[202:203], v24 offset:1536
  ds_read_b64_tr_b16 v[204:205], v25 offset:1024
  ds_read_b64_tr_b16 v[206:207], v25 offset:1536
  v_mfma_f32_32x32x16_bf16 v[80:95], v[32:35], v[144:147], 0
  ds_read_b128 v[112:115], v20 offset:16384
  ds_read_b128 v[116:119], v21 offset:16384
  ds_read_b128 v[120:123], v22 offset:16384
  ds_read_b128 v[124:127], v23 offset:16384
  v_add_f32 v9, 897988541, v110
  v_rcp_f32 v10, v9
  s_nop 0
  v_mul_f32 v96, v10, v96
  v_mul_f32 v97, v10, v97
  v_mul_f32 v98, v10, v98
  v_mul_f32 v99, v10, v99
  v_mfma_f32_32x32x16_bf16 v[80:95], v[36:39], v[148:151], v[80:95]
  ds_read_b64_tr_b16 v[208:209], v24 offset:4096
  ds_read_b64_tr_b16 v[210:211], v24 offset:4608
  v_cvt_pk_bf16_f32 v224, v96, v97
  v_mul_f32 v100, v10, v100
  v_mul_f32 v101, v10, v101
  v_cvt_pk_bf16_f32 v225, v98, v99
  v_mul_f32 v102, v10, v102
  v_mul_f32 v103, v10, v103
  s_waitcnt lgkmcnt(6)
  v_mfma_f32_32x32x16_bf16 v[64:79], v[196:199], v[40:43], v[64:79]
  ds_read_b64_tr_b16 v[212:213], v25 offset:4096
  ds_read_b64_tr_b16 v[214:215], v25 offset:4608
  v_cvt_pk_bf16_f32 v226, v100, v101
  v_mul_f32 v104, v10, v104
  v_mul_f32 v105, v10, v105
  v_cvt_pk_bf16_f32 v227, v102, v103
  v_mul_f32 v106, v10, v106
  v_mul_f32 v107, v10, v107
  v_mfma_f32_32x32x16_bf16 v[48:63], v[192:195], v[40:43], v[48:63]
  ds_read_b64_tr_b16 v[216:217], v24 offset:5120
  ds_read_b64_tr_b16 v[218:219], v24 offset:5632
  v_cvt_pk_bf16_f32 v228, v104, v105
  v_mul_f32 v108, v10, v108
  v_mul_f32 v109, v10, v109
  v_cvt_pk_bf16_f32 v229, v106, v107
  v_cvt_pk_bf16_f32 v230, v108, v109
  v_cvt_pk_bf16_f32 v32, v232, v233
  v_mfma_f32_32x32x16_bf16 v[64:79], v[204:207], v[44:47], v[64:79]
  ds_read_b64_tr_b16 v[220:221], v25 offset:5120
  ds_read_b64_tr_b16 v[222:223], v25 offset:5632
  v_cvt_pk_bf16_f32 v33, v234, v235
  v_cvt_pk_bf16_f32 v34, v236, v237
  v_cvt_pk_bf16_f32 v35, v238, v239
  v_cvt_pk_bf16_f32 v36, v240, v241
  v_cvt_pk_bf16_f32 v37, v242, v243
  v_cvt_pk_bf16_f32 v38, v244, v245
  v_mfma_f32_32x32x16_bf16 v[48:63], v[200:203], v[44:47], v[48:63]
  v_cvt_pk_bf16_f32 v39, v246, v247
  v_mfma_f32_32x32x16_bf16 v[96:111], v[32:35], v[152:155], 0
  ds_read_b128 v[232:235], v20 offset:20480
  ds_read_b128 v[236:239], v21 offset:20480
  ds_read_b128 v[240:243], v22 offset:20480
  ds_read_b128 v[244:247], v23 offset:20480
  v_add_f32 v9, 897988541, v94
  v_rcp_f32 v10, v9
  s_nop 0
  v_mul_f32 v80, v10, v80
  v_mul_f32 v81, v10, v81
  v_mul_f32 v82, v10, v82
  v_mul_f32 v83, v10, v83
  v_mfma_f32_32x32x16_bf16 v[96:111], v[36:39], v[156:159], v[96:111]
  ds_read_b64_tr_b16 v[192:193], v24 offset:8192
  ds_read_b64_tr_b16 v[194:195], v24 offset:8704
  v_cvt_pk_bf16_f32 v40, v80, v81
  v_mul_f32 v84, v10, v84
  v_mul_f32 v85, v10, v85
  v_cvt_pk_bf16_f32 v41, v82, v83
  v_mul_f32 v86, v10, v86
  v_mul_f32 v87, v10, v87
  s_waitcnt lgkmcnt(6)
  v_mfma_f32_32x32x16_bf16 v[64:79], v[212:215], v[224:227], v[64:79]
  ds_read_b64_tr_b16 v[196:197], v25 offset:8192
  ds_read_b64_tr_b16 v[198:199], v25 offset:8704
  v_cvt_pk_bf16_f32 v42, v84, v85
  v_mul_f32 v88, v10, v88
  v_mul_f32 v89, v10, v89
  v_cvt_pk_bf16_f32 v43, v86, v87
  v_mul_f32 v90, v10, v90
  v_mul_f32 v91, v10, v91
  v_mfma_f32_32x32x16_bf16 v[48:63], v[208:211], v[224:227], v[48:63]
  ds_read_b64_tr_b16 v[200:201], v24 offset:9216
  ds_read_b64_tr_b16 v[202:203], v24 offset:9728
  v_cvt_pk_bf16_f32 v44, v88, v89
  v_mul_f32 v92, v10, v92
  v_mul_f32 v93, v10, v93
  v_cvt_pk_bf16_f32 v45, v90, v91
  v_cvt_pk_bf16_f32 v46, v92, v93
  v_cvt_pk_bf16_f32 v32, v112, v113
  v_mfma_f32_32x32x16_bf16 v[64:79], v[220:223], v[228:231], v[64:79]
  ds_read_b64_tr_b16 v[204:205], v25 offset:9216
  ds_read_b64_tr_b16 v[206:207], v25 offset:9728
  v_cvt_pk_bf16_f32 v33, v114, v115
  v_cvt_pk_bf16_f32 v34, v116, v117
  v_cvt_pk_bf16_f32 v35, v118, v119
  v_cvt_pk_bf16_f32 v36, v120, v121
  v_cvt_pk_bf16_f32 v37, v122, v123
  v_cvt_pk_bf16_f32 v38, v124, v125
  v_mfma_f32_32x32x16_bf16 v[48:63], v[216:219], v[228:231], v[48:63]
  v_cvt_pk_bf16_f32 v39, v126, v127
  v_mfma_f32_32x32x16_bf16 v[80:95], v[32:35], v[160:163], 0
  ds_read_b128 v[112:115], v20 offset:24576
  ds_read_b128 v[116:119], v21 offset:24576
  ds_read_b128 v[120:123], v22 offset:24576
  ds_read_b128 v[124:127], v23 offset:24576
  v_add_f32 v9, 897988541, v110
  v_rcp_f32 v10, v9
  s_nop 0
  v_mul_f32 v96, v10, v96
  v_mul_f32 v97, v10, v97
  v_mul_f32 v98, v10, v98
  v_mul_f32 v99, v10, v99
  v_mfma_f32_32x32x16_bf16 v[80:95], v[36:39], v[164:167], v[80:95]
  ds_read_b64_tr_b16 v[208:209], v24 offset:12288
  ds_read_b64_tr_b16 v[210:211], v24 offset:12800
  v_cvt_pk_bf16_f32 v224, v96, v97
  v_mul_f32 v100, v10, v100
  v_mul_f32 v101, v10, v101
  v_cvt_pk_bf16_f32 v225, v98, v99
  v_mul_f32 v102, v10, v102
  v_mul_f32 v103, v10, v103
  s_waitcnt lgkmcnt(6)
  v_mfma_f32_32x32x16_bf16 v[64:79], v[196:199], v[40:43], v[64:79]
  ds_read_b64_tr_b16 v[212:213], v25 offset:12288
  ds_read_b64_tr_b16 v[214:215], v25 offset:12800
  v_cvt_pk_bf16_f32 v226, v100, v101
  v_mul_f32 v104, v10, v104
  v_mul_f32 v105, v10, v105
  v_cvt_pk_bf16_f32 v227, v102, v103
  v_mul_f32 v106, v10, v106
  v_mul_f32 v107, v10, v107
  v_mfma_f32_32x32x16_bf16 v[48:63], v[192:195], v[40:43], v[48:63]
  ds_read_b64_tr_b16 v[216:217], v24 offset:13312
  ds_read_b64_tr_b16 v[218:219], v24 offset:13824
  v_cvt_pk_bf16_f32 v228, v104, v105
  v_mul_f32 v108, v10, v108
  v_mul_f32 v109, v10, v109
  v_cvt_pk_bf16_f32 v229, v106, v107
  v_cvt_pk_bf16_f32 v230, v108, v109
  v_cvt_pk_bf16_f32 v32, v232, v233
  v_mfma_f32_32x32x16_bf16 v[64:79], v[204:207], v[44:47], v[64:79]
  ds_read_b64_tr_b16 v[220:221], v25 offset:13312
  ds_read_b64_tr_b16 v[222:223], v25 offset:13824
  v_cvt_pk_bf16_f32 v33, v234, v235
  v_cvt_pk_bf16_f32 v34, v236, v237
  v_cvt_pk_bf16_f32 v35, v238, v239
  v_cvt_pk_bf16_f32 v36, v240, v241
  v_cvt_pk_bf16_f32 v37, v242, v243
  v_cvt_pk_bf16_f32 v38, v244, v245
  v_mfma_f32_32x32x16_bf16 v[48:63], v[200:203], v[44:47], v[48:63]
  v_cvt_pk_bf16_f32 v39, v246, v247
  v_mfma_f32_32x32x16_bf16 v[96:111], v[32:35], v[168:171], 0
  ds_read_b128 v[232:235], v20 offset:28672
  ds_read_b128 v[236:239], v21 offset:28672
  ds_read_b128 v[240:243], v22 offset:28672
  ds_read_b128 v[244:247], v23 offset:28672
  v_add_f32 v9, 897988541, v94
  v_rcp_f32 v10, v9
  s_nop 0
  v_mul_f32 v80, v10, v80
  v_mul_f32 v81, v10, v81
  v_mul_f32 v82, v10, v82
  v_mul_f32 v83, v10, v83
  v_mfma_f32_32x32x16_bf16 v[96:111], v[36:39], v[172:175], v[96:111]
  ds_read_b64_tr_b16 v[192:193], v24 offset:16384
  ds_read_b64_tr_b16 v[194:195], v24 offset:16896
  v_cvt_pk_bf16_f32 v40, v80, v81
  v_mul_f32 v84, v10, v84
  v_mul_f32 v85, v10, v85
  v_cvt_pk_bf16_f32 v41, v82, v83
  v_mul_f32 v86, v10, v86
  v_mul_f32 v87, v10, v87
  s_waitcnt lgkmcnt(6)
  v_mfma_f32_32x32x16_bf16 v[64:79], v[212:215], v[224:227], v[64:79]
  ds_read_b64_tr_b16 v[196:197], v25 offset:16384
  ds_read_b64_tr_b16 v[198:199], v25 offset:16896
  v_cvt_pk_bf16_f32 v42, v84, v85
  v_mul_f32 v88, v10, v88
  v_mul_f32 v89, v10, v89
  v_cvt_pk_bf16_f32 v43, v86, v87
  v_mul_f32 v90, v10, v90
  v_mul_f32 v91, v10, v91
  v_mfma_f32_32x32x16_bf16 v[48:63], v[208:211], v[224:227], v[48:63]
  ds_read_b64_tr_b16 v[200:201], v24 offset:17408
  ds_read_b64_tr_b16 v[202:203], v24 offset:17920
  v_cvt_pk_bf16_f32 v44, v88, v89
  v_mul_f32 v92, v10, v92
  v_mul_f32 v93, v10, v93
  v_cvt_pk_bf16_f32 v45, v90, v91
  v_cvt_pk_bf16_f32 v46, v92, v93
  v_cvt_pk_bf16_f32 v32, v112, v113
  v_mfma_f32_32x32x16_bf16 v[64:79], v[220:223], v[228:231], v[64:79]
  ds_read_b64_tr_b16 v[204:205], v25 offset:17408
  ds_read_b64_tr_b16 v[206:207], v25 offset:17920
  v_cvt_pk_bf16_f32 v33, v114, v115
  v_cvt_pk_bf16_f32 v34, v116, v117
  v_cvt_pk_bf16_f32 v35, v118, v119
  v_cvt_pk_bf16_f32 v36, v120, v121
  v_cvt_pk_bf16_f32 v37, v122, v123
  v_cvt_pk_bf16_f32 v38, v124, v125
  v_mfma_f32_32x32x16_bf16 v[48:63], v[216:219], v[228:231], v[48:63]
  v_cvt_pk_bf16_f32 v39, v126, v127
  v_mfma_f32_32x32x16_bf16 v[80:95], v[32:35], v[176:179], 0
  v_add_f32 v9, 897988541, v110
  v_rcp_f32 v10, v9
  s_nop 0
  v_mul_f32 v96, v10, v96
  v_mul_f32 v97, v10, v97
  v_mul_f32 v98, v10, v98
  v_mul_f32 v99, v10, v99
  v_mfma_f32_32x32x16_bf16 v[80:95], v[36:39], v[180:183], v[80:95]
  ds_read_b64_tr_b16 v[208:209], v24 offset:20480
  ds_read_b64_tr_b16 v[210:211], v24 offset:20992
  v_cvt_pk_bf16_f32 v224, v96, v97
  v_mul_f32 v100, v10, v100
  v_mul_f32 v101, v10, v101
  v_cvt_pk_bf16_f32 v225, v98, v99
  v_mul_f32 v102, v10, v102
  v_mul_f32 v103, v10, v103
  s_waitcnt lgkmcnt(2)
  v_mfma_f32_32x32x16_bf16 v[64:79], v[196:199], v[40:43], v[64:79]
  ds_read_b64_tr_b16 v[212:213], v25 offset:20480
  ds_read_b64_tr_b16 v[214:215], v25 offset:20992
  v_cvt_pk_bf16_f32 v226, v100, v101
  v_mul_f32 v104, v10, v104
  v_mul_f32 v105, v10, v105
  v_cvt_pk_bf16_f32 v227, v102, v103
  v_mul_f32 v106, v10, v106
  v_mul_f32 v107, v10, v107
  v_mfma_f32_32x32x16_bf16 v[48:63], v[192:195], v[40:43], v[48:63]
  ds_read_b64_tr_b16 v[216:217], v24 offset:21504
  ds_read_b64_tr_b16 v[218:219], v24 offset:22016
  v_cvt_pk_bf16_f32 v228, v104, v105
  v_mul_f32 v108, v10, v108
  v_mul_f32 v109, v10, v109
  v_cvt_pk_bf16_f32 v229, v106, v107
  v_cvt_pk_bf16_f32 v230, v108, v109
  v_cvt_pk_bf16_f32 v32, v232, v233
  v_mfma_f32_32x32x16_bf16 v[64:79], v[204:207], v[44:47], v[64:79]
  ds_read_b64_tr_b16 v[220:221], v25 offset:21504
  ds_read_b64_tr_b16 v[222:223], v25 offset:22016
  v_cvt_pk_bf16_f32 v33, v234, v235
  v_cvt_pk_bf16_f32 v34, v236, v237
  v_cvt_pk_bf16_f32 v35, v238, v239
  v_cvt_pk_bf16_f32 v36, v240, v241
  v_cvt_pk_bf16_f32 v37, v242, v243
  v_cvt_pk_bf16_f32 v38, v244, v245
  v_mfma_f32_32x32x16_bf16 v[48:63], v[200:203], v[44:47], v[48:63]
  v_cvt_pk_bf16_f32 v39, v246, v247
  v_mfma_f32_32x32x16_bf16 v[96:111], v[32:35], v[184:187], 0
  v_add_f32 v9, 897988541, v94
  v_rcp_f32 v10, v9
  s_nop 0
  v_mul_f32 v80, v10, v80
  v_mul_f32 v81, v10, v81
  v_mfma_f32_32x32x16_bf16 v[96:111], v[36:39], v[188:191], v[96:111]
  ds_read_b64_tr_b16 v[192:193], v24 offset:24576
  ds_read_b64_tr_b16 v[194:195], v24 offset:25088
  v_mul_f32 v82, v10, v82
  v_mul_f32 v83, v10, v83
  v_cvt_pk_bf16_f32 v40, v80, v81
  v_mul_f32 v84, v10, v84
  s_waitcnt lgkmcnt(2)
  v_mfma_f32_32x32x16_bf16 v[64:79], v[212:215], v[224:227], v[64:79]
  ds_read_b64_tr_b16 v[196:197], v25 offset:24576
  ds_read_b64_tr_b16 v[198:199], v25 offset:25088
  v_mul_f32 v85, v10, v85
  v_cvt_pk_bf16_f32 v41, v82, v83
  v_mul_f32 v86, v10, v86
  v_mul_f32 v87, v10, v87
  v_mfma_f32_32x32x16_bf16 v[48:63], v[208:211], v[224:227], v[48:63]
  ds_read_b64_tr_b16 v[200:201], v24 offset:25600
  ds_read_b64_tr_b16 v[202:203], v24 offset:26112
  v_cvt_pk_bf16_f32 v42, v84, v85
  v_mul_f32 v88, v10, v88
  v_mul_f32 v89, v10, v89
  v_cvt_pk_bf16_f32 v43, v86, v87
  v_mfma_f32_32x32x16_bf16 v[64:79], v[220:223], v[228:231], v[64:79]
  ds_read_b64_tr_b16 v[204:205], v25 offset:25600
  ds_read_b64_tr_b16 v[206:207], v25 offset:26112
  v_mul_f32 v90, v10, v90
  v_mul_f32 v91, v10, v91
  v_cvt_pk_bf16_f32 v44, v88, v89
  v_mul_f32 v92, v10, v92
  v_mfma_f32_32x32x16_bf16 v[48:63], v[216:219], v[228:231], v[48:63]
  v_mul_f32 v93, v10, v93
  v_cvt_pk_bf16_f32 v45, v90, v91
  v_cvt_pk_bf16_f32 v46, v92, v93
  s_waitcnt lgkmcnt(0)
  v_mfma_f32_32x32x16_bf16 v[64:79], v[196:199], v[40:43], v[64:79]
  v_add_f32 v9, 897988541, v110
  v_rcp_f32 v10, v9
  s_nop 0
  v_mul_f32 v96, v10, v96
  v_mul_f32 v97, v10, v97
  v_mul_f32 v98, v10, v98
  v_mul_f32 v99, v10, v99
  v_mfma_f32_32x32x16_bf16 v[48:63], v[192:195], v[40:43], v[48:63]
  ds_read_b64_tr_b16 v[208:209], v24 offset:28672
  ds_read_b64_tr_b16 v[210:211], v24 offset:29184
  v_cvt_pk_bf16_f32 v224, v96, v97
  v_mul_f32 v100, v10, v100
  v_mul_f32 v101, v10, v101
  v_cvt_pk_bf16_f32 v225, v98, v99
  v_mul_f32 v102, v10, v102
  v_mul_f32 v103, v10, v103
  v_mfma_f32_32x32x16_bf16 v[64:79], v[204:207], v[44:47], v[64:79]
  ds_read_b64_tr_b16 v[212:213], v25 offset:28672
  ds_read_b64_tr_b16 v[214:215], v25 offset:29184
  v_cvt_pk_bf16_f32 v226, v100, v101
  v_mul_f32 v104, v10, v104
  v_mul_f32 v105, v10, v105
  v_cvt_pk_bf16_f32 v227, v102, v103
  v_mul_f32 v106, v10, v106
  v_mul_f32 v107, v10, v107
  v_mfma_f32_32x32x16_bf16 v[48:63], v[200:203], v[44:47], v[48:63]
  ds_read_b64_tr_b16 v[216:217], v24 offset:29696
  ds_read_b64_tr_b16 v[218:219], v24 offset:30208
  v_cvt_pk_bf16_f32 v228, v104, v105
  v_mul_f32 v108, v10, v108
  v_mul_f32 v109, v10, v109
  v_cvt_pk_bf16_f32 v229, v106, v107
  v_cvt_pk_bf16_f32 v230, v108, v109
  ds_read_b64_tr_b16 v[220:221], v25 offset:29696
  ds_read_b64_tr_b16 v[222:223], v25 offset:30208
  s_waitcnt lgkmcnt(0)
  v_mfma_f32_32x32x16_bf16 v[64:79], v[212:215], v[224:227], v[64:79]
  v_mfma_f32_32x32x16_bf16 v[48:63], v[208:211], v[224:227], v[48:63]
  v_mfma_f32_32x32x16_bf16 v[64:79], v[220:223], v[228:231], v[64:79]
  v_mfma_f32_32x32x16_bf16 v[48:63], v[216:219], v[228:231], v[48:63]
  s_nop 10
  ds_write_b128 v26, v[64:67] offset:0
  ds_write_b128 v26, v[68:71] offset:1024
  ds_write_b128 v26, v[72:75] offset:2048
  ds_write_b128 v26, v[76:79] offset:3072
  s_waitcnt lgkmcnt(0)
  s_barrier
  ds_read_b128 v[96:99], v27 offset:0
  ds_read_b128 v[100:103], v27 offset:1024
  ds_read_b128 v[104:107], v27 offset:2048
  ds_read_b128 v[108:111], v27 offset:3072
  s_waitcnt lgkmcnt(3)
  v_pk_add_f32 v[48:49], v[48:49], v[96:97]
  v_pk_add_f32 v[50:51], v[50:51], v[98:99]
  v_cvt_pk_bf16_f32 v80, v48, v49
  v_cvt_pk_bf16_f32 v81, v50, v51
  ds_write_b64 v14, v[80:81]
  s_waitcnt lgkmcnt(3)
  v_pk_add_f32 v[52:53], v[52:53], v[100:101]
  v_pk_add_f32 v[54:55], v[54:55], v[102:103]
  v_cvt_pk_bf16_f32 v82, v52, v53
  v_cvt_pk_bf16_f32 v83, v54, v55
  ds_write_b64 v15, v[82:83]
  s_waitcnt lgkmcnt(3)
  v_pk_add_f32 v[56:57], v[56:57], v[104:105]
  v_pk_add_f32 v[58:59], v[58:59], v[106:107]
  v_cvt_pk_bf16_f32 v84, v56, v57
  v_cvt_pk_bf16_f32 v85, v58, v59
  ds_write_b64 v16, v[84:85]
  s_waitcnt lgkmcnt(3)
  v_pk_add_f32 v[60:61], v[60:61], v[108:109]
  v_pk_add_f32 v[62:63], v[62:63], v[110:111]
  v_cvt_pk_bf16_f32 v86, v60, v61
  v_cvt_pk_bf16_f32 v87, v62, v63
  ds_write_b64 v17, v[86:87]
  ds_read_b128 v[88:91], v29
  ds_read_b128 v[92:95], v29 offset:1024
  s_waitcnt lgkmcnt(1)
  buffer_store_dwordx4 v[88:91], v28, s[64:67], s46 offen
  s_waitcnt lgkmcnt(0)
  buffer_store_dwordx4 v[92:95], v28, s[64:67], s47 offen
  s_branch L_end_concat_heads__ssm_conv_s4__linear_attn_block__prompt_kernel
  s_nop 0
L_roleA_concat_heads__ssm_conv_s4__linear_attn_block__prompt_kernel:
  s_cmp_lt_u32 s2, 240
  s_cbranch_scc1 L_roleA_concat_heads__ssm_conv_s4__linear_attn_block__prompt_kernel2
  s_sub_u32 s4, s2, 240
  s_and_b32 s6, s3, 3
  s_cmp_ge_u32 s3, 4
  s_cbranch_scc1 Lhs_20
  v_lshrrev_b32 v2, 3, v1
  v_and_b32 v3, 7, v1
  v_lshrrev_b32 v4, 4, v1
  v_xor_b32 v3, v3, v4
  s_lshl_b32 s8, s4, 7
  s_lshl_b32 s9, s6, 5
  s_add_u32 s8, s8, s9
  v_add_u32 v2, s8, v2
  v_mul_u32_u24 v2, 896, v2
  v_lshl_add_u32 v6, v3, 4, v2
  v_xor_b32 v3, 4, v3
  v_lshl_add_u32 v7, v3, 4, v2
  s_lshl_b32 s9, s6, 12
  s_waitcnt lgkmcnt(0)
  s_mov_b32 s48, s16
  s_mov_b32 s49, s17
  s_mov_b32 s50, 1835008
  s_mov_b32 s51, 0x00020000
  s_add_u32 m0, s9, 0
  s_movk_i32 s8, 0
  buffer_load_dwordx4 v6, s[48:51], s8 offen lds
  s_add_u32 m0, s9, 1024
  s_movk_i32 s8, 7168
  buffer_load_dwordx4 v7, s[48:51], s8 offen lds
  s_add_u32 m0, s9, 2048
  s_movk_i32 s8, 14336
  buffer_load_dwordx4 v6, s[48:51], s8 offen lds
  s_add_u32 m0, s9, 3072
  s_movk_i32 s8, 21504
  buffer_load_dwordx4 v7, s[48:51], s8 offen lds
  s_add_u32 m0, s9, 16384
  s_movk_i32 s8, 128
  buffer_load_dwordx4 v6, s[48:51], s8 offen lds
  s_add_u32 m0, s9, 17408
  s_movk_i32 s8, 7296
  buffer_load_dwordx4 v7, s[48:51], s8 offen lds
  s_add_u32 m0, s9, 18432
  s_movk_i32 s8, 14464
  buffer_load_dwordx4 v6, s[48:51], s8 offen lds
  s_add_u32 m0, s9, 19456
  s_movk_i32 s8, 21632
  buffer_load_dwordx4 v7, s[48:51], s8 offen lds
  s_add_u32 m0, s9, 32768
  s_movk_i32 s8, 256
  buffer_load_dwordx4 v6, s[48:51], s8 offen lds
  s_add_u32 m0, s9, 33792
  s_movk_i32 s8, 7424
  buffer_load_dwordx4 v7, s[48:51], s8 offen lds
  s_add_u32 m0, s9, 34816
  s_movk_i32 s8, 14592
  buffer_load_dwordx4 v6, s[48:51], s8 offen lds
  s_add_u32 m0, s9, 35840
  s_movk_i32 s8, 21760
  buffer_load_dwordx4 v7, s[48:51], s8 offen lds
  s_waitcnt vmcnt(8)
  s_barrier
  s_add_u32 m0, s9, 49152
  s_movk_i32 s8, 384
  buffer_load_dwordx4 v6, s[48:51], s8 offen lds
  s_add_u32 m0, s9, 50176
  s_movk_i32 s8, 7552
  buffer_load_dwordx4 v7, s[48:51], s8 offen lds
  s_add_u32 m0, s9, 51200
  s_movk_i32 s8, 14720
  buffer_load_dwordx4 v6, s[48:51], s8 offen lds
  s_add_u32 m0, s9, 52224
  s_movk_i32 s8, 21888
  buffer_load_dwordx4 v7, s[48:51], s8 offen lds
  s_add_u32 m0, s9, 65536
  s_movk_i32 s8, 512
  buffer_load_dwordx4 v6, s[48:51], s8 offen lds
  s_add_u32 m0, s9, 66560
  s_movk_i32 s8, 7680
  buffer_load_dwordx4 v7, s[48:51], s8 offen lds
  s_add_u32 m0, s9, 67584
  s_movk_i32 s8, 14848
  buffer_load_dwordx4 v6, s[48:51], s8 offen lds
  s_add_u32 m0, s9, 68608
  s_movk_i32 s8, 22016
  buffer_load_dwordx4 v7, s[48:51], s8 offen lds
  s_waitcnt vmcnt(8)
  s_barrier
  s_add_u32 m0, s9, 81920
  s_movk_i32 s8, 640
  buffer_load_dwordx4 v6, s[48:51], s8 offen lds
  s_add_u32 m0, s9, 82944
  s_movk_i32 s8, 7808
  buffer_load_dwordx4 v7, s[48:51], s8 offen lds
  s_add_u32 m0, s9, 83968
  s_movk_i32 s8, 14976
  buffer_load_dwordx4 v6, s[48:51], s8 offen lds
  s_add_u32 m0, s9, 84992
  s_movk_i32 s8, 22144
  buffer_load_dwordx4 v7, s[48:51], s8 offen lds
  s_add_u32 m0, s9, 98304
  s_movk_i32 s8, 768
  buffer_load_dwordx4 v6, s[48:51], s8 offen lds
  s_add_u32 m0, s9, 99328
  s_movk_i32 s8, 7936
  buffer_load_dwordx4 v7, s[48:51], s8 offen lds
  s_add_u32 m0, s9, 100352
  s_movk_i32 s8, 15104
  buffer_load_dwordx4 v6, s[48:51], s8 offen lds
  s_add_u32 m0, s9, 101376
  s_movk_i32 s8, 22272
  buffer_load_dwordx4 v7, s[48:51], s8 offen lds
  s_waitcnt vmcnt(8)
  s_barrier
  s_waitcnt vmcnt(0)
  s_barrier
  s_branch L_end_concat_heads__ssm_conv_s4__linear_attn_block__prompt_kernel
Lhs_20:
  v_mov_b32 v212, 0
  v_and_b32 v8, 7, v1
  s_lshl_b32 s8, s6, 1
  v_xor_b32 v8, s8, v8
  v_lshlrev_b32 v24, 8, v1
  v_lshl_add_u32 v24, v8, 4, v24
  v_xor_b32 v25, 16, v24
  v_add_u32 v26, 0x10000, v24
  v_add_u32 v27, 0x10000, v25
  v_lshlrev_b32 v28, 4, v1
  s_lshl_b32 s10, s6, 16
  s_lshl_b32 s9, s4, 10
  s_add_u32 s10, s10, s9
  s_mul_i32 s11, s4, 28
  s_add_u32 s11, s11, s6
  s_lshl_b32 s11, s11, 7
  s_add_u32 s11, s11, 4456448
  s_waitcnt lgkmcnt(0)
  s_mov_b32 s56, s44
  s_mov_b32 s57, s45
  s_mov_b32 s58, 16777216
  s_mov_b32 s59, 0x00020000
  s_barrier
  global_load_dword v213, v212, s[42:43] sc1
  ds_read_b64 v[32:33], v24 offset:0
  ds_read_b64 v[34:35], v24 offset:128
  ds_read_b64 v[36:37], v24 offset:8
  ds_read_b64 v[38:39], v24 offset:136
  ds_read_b64 v[40:41], v25 offset:0
  ds_read_b64 v[42:43], v25 offset:128
  ds_read_b64 v[44:45], v25 offset:8
  ds_read_b64 v[46:47], v25 offset:136
  s_add_u32 s8, s10, 0
  s_waitcnt lgkmcnt(6)
  buffer_store_dwordx4 v[32:35], v28, s[56:59], s8 offen sc0 sc1
  s_add_u32 s8, s10, 16384
  s_waitcnt lgkmcnt(4)
  buffer_store_dwordx4 v[36:39], v28, s[56:59], s8 offen sc0 sc1
  s_add_u32 s8, s10, 32768
  s_waitcnt lgkmcnt(2)
  buffer_store_dwordx4 v[40:43], v28, s[56:59], s8 offen sc0 sc1
  s_add_u32 s8, s10, 49152
  s_waitcnt lgkmcnt(0)
  buffer_store_dwordx4 v[44:47], v28, s[56:59], s8 offen sc0 sc1
  s_barrier
  ds_read_b64 v[48:49], v24 offset:16384
  ds_read_b64 v[50:51], v24 offset:16512
  ds_read_b64 v[52:53], v24 offset:16392
  ds_read_b64 v[54:55], v24 offset:16520
  ds_read_b64 v[56:57], v25 offset:16384
  ds_read_b64 v[58:59], v25 offset:16512
  ds_read_b64 v[60:61], v25 offset:16392
  ds_read_b64 v[62:63], v25 offset:16520
  s_add_u32 s8, s10, 262144
  s_waitcnt lgkmcnt(6)
  buffer_store_dwordx4 v[48:51], v28, s[56:59], s8 offen sc0 sc1
  s_add_u32 s8, s10, 278528
  s_waitcnt lgkmcnt(4)
  buffer_store_dwordx4 v[52:55], v28, s[56:59], s8 offen sc0 sc1
  s_add_u32 s8, s10, 294912
  s_waitcnt lgkmcnt(2)
  buffer_store_dwordx4 v[56:59], v28, s[56:59], s8 offen sc0 sc1
  s_add_u32 s8, s10, 311296
  s_waitcnt lgkmcnt(0)
  buffer_store_dwordx4 v[60:63], v28, s[56:59], s8 offen sc0 sc1
  ds_read_b64 v[64:65], v24 offset:32768
  ds_read_b64 v[66:67], v24 offset:32896
  ds_read_b64 v[68:69], v24 offset:32776
  ds_read_b64 v[70:71], v24 offset:32904
  ds_read_b64 v[72:73], v25 offset:32768
  ds_read_b64 v[74:75], v25 offset:32896
  ds_read_b64 v[76:77], v25 offset:32776
  ds_read_b64 v[78:79], v25 offset:32904
  s_add_u32 s8, s10, 524288
  s_waitcnt lgkmcnt(6)
  buffer_store_dwordx4 v[64:67], v28, s[56:59], s8 offen sc0 sc1
  s_add_u32 s8, s10, 540672
  s_waitcnt lgkmcnt(4)
  buffer_store_dwordx4 v[68:71], v28, s[56:59], s8 offen sc0 sc1
  s_add_u32 s8, s10, 557056
  s_waitcnt lgkmcnt(2)
  buffer_store_dwordx4 v[72:75], v28, s[56:59], s8 offen sc0 sc1
  s_add_u32 s8, s10, 573440
  s_waitcnt lgkmcnt(0)
  buffer_store_dwordx4 v[76:79], v28, s[56:59], s8 offen sc0 sc1
  s_waitcnt vmcnt(8)
  v_readfirstlane_b32 s74, v213
  s_nop 0
  s_cmp_lg_u32 s74, 0
  s_cbranch_scc1 Lhn_21
  v_mov_b32 v212, 0
  s_mov_b32 s8, 0
Lnn_22:
  global_load_dword v213, v212, s[42:43] sc1
  s_waitcnt vmcnt(0)
  v_readfirstlane_b32 s74, v213
  s_add_u32 s8, s8, 1
  s_cmp_lg_u32 s74, 0
  s_cbranch_scc1 Lnd_23
  s_sleep 1
  s_cmp_lt_u32 s8, 200000
  s_cbranch_scc1 Lnn_22
Lnd_23:
Lhn_21:
  s_mov_b64 exec, 1
  s_add_u32 s8, s11, 0
  buffer_store_dword v213, v212, s[56:59], s8 offen sc0 sc1
  s_mov_b64 exec, -1
  s_barrier
  ds_read_b64 v[80:81], v24 offset:49152
  ds_read_b64 v[82:83], v24 offset:49280
  ds_read_b64 v[84:85], v24 offset:49160
  ds_read_b64 v[86:87], v24 offset:49288
  ds_read_b64 v[88:89], v25 offset:49152
  ds_read_b64 v[90:91], v25 offset:49280
  ds_read_b64 v[92:93], v25 offset:49160
  ds_read_b64 v[94:95], v25 offset:49288
  s_add_u32 s8, s10, 786432
  s_waitcnt lgkmcnt(6)
  buffer_store_dwordx4 v[80:83], v28, s[56:59], s8 offen sc0 sc1
  s_add_u32 s8, s10, 802816
  s_waitcnt lgkmcnt(4)
  buffer_store_dwordx4 v[84:87], v28, s[56:59], s8 offen sc0 sc1
  s_add_u32 s8, s10, 819200
  s_waitcnt lgkmcnt(2)
  buffer_store_dwordx4 v[88:91], v28, s[56:59], s8 offen sc0 sc1
  s_add_u32 s8, s10, 835584
  s_waitcnt lgkmcnt(0)
  buffer_store_dwordx4 v[92:95], v28, s[56:59], s8 offen sc0 sc1
  ds_read_b64 v[96:97], v26 offset:0
  ds_read_b64 v[98:99], v26 offset:128
  ds_read_b64 v[100:101], v26 offset:8
  ds_read_b64 v[102:103], v26 offset:136
  ds_read_b64 v[104:105], v27 offset:0
  ds_read_b64 v[106:107], v27 offset:128
  ds_read_b64 v[108:109], v27 offset:8
  ds_read_b64 v[110:111], v27 offset:136
  s_add_u32 s8, s10, 1048576
  s_waitcnt lgkmcnt(6)
  buffer_store_dwordx4 v[96:99], v28, s[56:59], s8 offen sc0 sc1
  s_add_u32 s8, s10, 1064960
  s_waitcnt lgkmcnt(4)
  buffer_store_dwordx4 v[100:103], v28, s[56:59], s8 offen sc0 sc1
  s_add_u32 s8, s10, 1081344
  s_waitcnt lgkmcnt(2)
  buffer_store_dwordx4 v[104:107], v28, s[56:59], s8 offen sc0 sc1
  s_add_u32 s8, s10, 1097728
  s_waitcnt lgkmcnt(0)
  buffer_store_dwordx4 v[108:111], v28, s[56:59], s8 offen sc0 sc1
  s_waitcnt vmcnt(9)
  s_mov_b64 exec, 1
  s_add_u32 s8, s11, 512
  buffer_store_dword v213, v212, s[56:59], s8 offen sc0 sc1
  s_add_u32 s8, s11, 1024
  buffer_store_dword v213, v212, s[56:59], s8 offen sc0 sc1
  s_mov_b64 exec, -1
  s_barrier
  ds_read_b64 v[112:113], v26 offset:16384
  ds_read_b64 v[114:115], v26 offset:16512
  ds_read_b64 v[116:117], v26 offset:16392
  ds_read_b64 v[118:119], v26 offset:16520
  ds_read_b64 v[120:121], v27 offset:16384
  ds_read_b64 v[122:123], v27 offset:16512
  ds_read_b64 v[124:125], v27 offset:16392
  ds_read_b64 v[126:127], v27 offset:16520
  s_add_u32 s8, s10, 1310720
  s_waitcnt lgkmcnt(6)
  buffer_store_dwordx4 v[112:115], v28, s[56:59], s8 offen sc0 sc1
  s_add_u32 s8, s10, 1327104
  s_waitcnt lgkmcnt(4)
  buffer_store_dwordx4 v[116:119], v28, s[56:59], s8 offen sc0 sc1
  s_add_u32 s8, s10, 1343488
  s_waitcnt lgkmcnt(2)
  buffer_store_dwordx4 v[120:123], v28, s[56:59], s8 offen sc0 sc1
  s_add_u32 s8, s10, 1359872
  s_waitcnt lgkmcnt(0)
  buffer_store_dwordx4 v[124:127], v28, s[56:59], s8 offen sc0 sc1
  ds_read_b64 v[128:129], v26 offset:32768
  ds_read_b64 v[130:131], v26 offset:32896
  ds_read_b64 v[132:133], v26 offset:32776
  ds_read_b64 v[134:135], v26 offset:32904
  ds_read_b64 v[136:137], v27 offset:32768
  ds_read_b64 v[138:139], v27 offset:32896
  ds_read_b64 v[140:141], v27 offset:32776
  ds_read_b64 v[142:143], v27 offset:32904
  s_add_u32 s8, s10, 1572864
  s_waitcnt lgkmcnt(6)
  buffer_store_dwordx4 v[128:131], v28, s[56:59], s8 offen sc0 sc1
  s_add_u32 s8, s10, 1589248
  s_waitcnt lgkmcnt(4)
  buffer_store_dwordx4 v[132:135], v28, s[56:59], s8 offen sc0 sc1
  s_add_u32 s8, s10, 1605632
  s_waitcnt lgkmcnt(2)
  buffer_store_dwordx4 v[136:139], v28, s[56:59], s8 offen sc0 sc1
  s_add_u32 s8, s10, 1622016
  s_waitcnt lgkmcnt(0)
  buffer_store_dwordx4 v[140:143], v28, s[56:59], s8 offen sc0 sc1
  s_waitcnt vmcnt(10)
  s_mov_b64 exec, 1
  s_add_u32 s8, s11, 1536
  buffer_store_dword v213, v212, s[56:59], s8 offen sc0 sc1
  s_add_u32 s8, s11, 2048
  buffer_store_dword v213, v212, s[56:59], s8 offen sc0 sc1
  s_mov_b64 exec, -1
  s_waitcnt vmcnt(2)
  s_mov_b64 exec, 1
  s_add_u32 s8, s11, 2560
  buffer_store_dword v213, v212, s[56:59], s8 offen sc0 sc1
  s_add_u32 s8, s11, 3072
  buffer_store_dword v213, v212, s[56:59], s8 offen sc0 sc1
  s_mov_b64 exec, -1
  s_waitcnt vmcnt(0)
  s_branch L_end_concat_heads__ssm_conv_s4__linear_attn_block__prompt_kernel
L_roleA_concat_heads__ssm_conv_s4__linear_attn_block__prompt_kernel2:
  s_sub_u32 s4, s2, 128
  s_and_b32 s6, s4, 7
  s_mul_i32 s5, s6, 14
  s_lshr_b32 s7, s4, 3
  s_add_u32 s5, s5, s7
  s_lshl_b32 s8, s5, 11
  v_lshl_add_u32 v5, v0, 2, s8
  v_mov_b32 v212, 0
  v_mov_b32 v213, 0
  v_mov_b32 v211, 138368
  ds_write_b32 v211, v212
  s_waitcnt lgkmcnt(0)
  s_mov_b32 s56, s44
  s_mov_b32 s57, s45
  s_mov_b32 s58, 16777216
  s_mov_b32 s59, 0x00020000
  s_cmp_ge_u32 s4, 16
  s_cbranch_scc1 Linit_24
  s_cmp_lg_u32 s3, 7
  s_cbranch_scc1 Linit_24
  v_mov_b32 v20, 0
  v_mov_b32 v21, 0
  v_mov_b32 v22, 0
  v_mov_b32 v23, 0
  v_lshlrev_b32 v8, 4, v1
  s_lshl_b32 s8, s4, 12
  s_add_u32 s8, s8, 4194304
  buffer_store_dwordx4 v[20:23], v8, s[56:59], s8 offen offset:0 sc0 sc1
  buffer_store_dwordx4 v[20:23], v8, s[56:59], s8 offen offset:1024 sc0 sc1
  buffer_store_dwordx4 v[20:23], v8, s[56:59], s8 offen offset:2048 sc0 sc1
  buffer_store_dwordx4 v[20:23], v8, s[56:59], s8 offen offset:3072 sc0 sc1
Linit_24:
  global_load_dword v10, v5, s[18:19]
  global_load_dword v11, v5, s[20:21]
  global_load_dword v12, v5, s[22:23]
  global_load_dword v13, v5, s[24:25]
  global_load_dword v14, v5, s[26:27]
  global_load_dword v15, v5, s[28:29]
  s_lshl_b32 s8, s5, 3
  s_load_dwordx2 s[12:13], s[30:31], s8
  s_load_dwordx2 s[14:15], s[32:33], s8
  s_mov_b32 s64, s40
  s_mov_b32 s65, s41
  s_mov_b32 s66, 3670016
  s_mov_b32 s67, 0x00020000
  s_mov_b32 s52, s36
  s_mov_b32 s53, s37
  s_mov_b32 s54, 1204224
  s_mov_b32 s55, 0x00020000
  s_mov_b32 s60, s34
  s_mov_b32 s61, s35
  s_mov_b32 s62, 1835008
  s_mov_b32 s63, 0x00020000
  s_mov_b32 s72, s38
  s_mov_b32 s73, s39
  s_mov_b32 s74, 401408
  s_mov_b32 s75, 0x00020000
  s_mul_i32 s8, s3, 14
  s_add_u32 s8, s8, s7
  s_add_u32 s8, s8, 25
  s_barrier
  v_lshlrev_b32 v18, 7, v1
  v_mul_u32_u24 v19, 896, v1
  s_cmp_ge_u32 s8, 175
  s_cbranch_scc1 Lto_26
  s_mul_i32 s9, s8, 2622
  s_lshr_b32 s9, s9, 16
  s_mul_i32 s10, s9, 25
  s_sub_u32 s10, s8, s10
  s_cmp_lt_u32 s10, 4
  s_cbranch_scc1 Ltx_25
  s_mul_i32 s9, s9, 21
  s_add_u32 s9, s9, s10
  s_sub_u32 s9, s9, 4
  s_lshl_b32 s9, s9, 13
  buffer_load_dword v16, v18, s[52:55], s9 offen
  s_branch Ltj_27
Ltx_25:
  s_lshl_b32 s11, s6, 2
  s_add_u32 s10, s10, s11
  s_mul_i32 s10, s10, 57344
  s_lshl_b32 s9, s9, 7
  s_add_u32 s9, s9, s10
  buffer_load_dword v16, v19, s[60:63], s9 offen
  s_branch Ltj_27
Lto_26:
  s_sub_u32 s9, s8, 175
  s_lshl_b32 s9, s9, 13
  buffer_load_dword v16, v18, s[72:75], s9 offen
Ltj_27:
  s_add_u32 s9, s8, 112
  s_cmp_lt_u32 s9, 175
  s_cbranch_scc0 Lt2_28
  s_mov_b32 s8, s9
  v_lshlrev_b32 v18, 7, v1
  v_mul_u32_u24 v19, 896, v1
  s_cmp_ge_u32 s8, 175
  s_cbranch_scc1 Lto_30
  s_mul_i32 s9, s8, 2622
  s_lshr_b32 s9, s9, 16
  s_mul_i32 s10, s9, 25
  s_sub_u32 s10, s8, s10
  s_cmp_lt_u32 s10, 4
  s_cbranch_scc1 Ltx_29
  s_mul_i32 s9, s9, 21
  s_add_u32 s9, s9, s10
  s_sub_u32 s9, s9, 4
  s_lshl_b32 s9, s9, 13
  buffer_load_dword v17, v18, s[52:55], s9 offen
  s_branch Ltj_31
Ltx_29:
  s_lshl_b32 s11, s6, 2
  s_add_u32 s10, s10, s11
  s_mul_i32 s10, s10, 57344
  s_lshl_b32 s9, s9, 7
  s_add_u32 s9, s9, s10
  buffer_load_dword v17, v19, s[60:63], s9 offen
  s_branch Ltj_31
Lto_30:
  s_sub_u32 s9, s8, 175
  s_lshl_b32 s9, s9, 13
  buffer_load_dword v17, v18, s[72:75], s9 offen
Ltj_31:
Lt2_28:
  s_mov_b32 s71, s8
  s_mul_i32 s72, s3, 4608
  v_and_b32 v2, 15, v1
  v_lshrrev_b32 v3, 4, v1
  v_mul_u32_u24 v4, 288, v2
  v_lshl_add_u32 v4, v3, 4, v4
  v_add_u32 v4, s72, v4
  v_mov_b32 v9, 0x3f80
  v_mov_b32 v160, 0
  v_mov_b32 v161, 0
  v_mov_b32 v162, 0
  v_mov_b32 v163, 0
  v_mov_b32 v164, 0
  v_mov_b32 v165, 0
  v_mov_b32 v166, 0
  v_mov_b32 v167, 0
  v_mov_b32 v168, 0
  v_mov_b32 v169, 0
  v_mov_b32 v170, 0
  v_mov_b32 v171, 0
  s_waitcnt lgkmcnt(0)
  s_lshr_b32 s8, s3, 1
  s_lshl_b32 s8, s8, 4
  s_lshr_b64 s[12:13], s[12:13], s8
  s_lshl_b32 s10, s12, 16
  s_lshr_b64 s[14:15], s[14:15], s8
  s_lshl_b32 s69, s14, 16
  s_lshr_b32 s14, s3, 1
  s_and_b32 s15, s3, 1
  v_mov_b32 v6, 1069066811
  v_mul_f32 v6, s10, v6
  v_exp_f32 v6, v6
  s_nop 0
  v_cvt_pk_bf16_f32 v6, v6, v6
  v_lshlrev_b32 v6, 16, v6
  s_nop 0
  v_readfirstlane_b32 s68, v6
  v_and_b32 v8, 1, v1
  v_mul_u32_u24 v8, 28, v8
  s_mul_i32 s8, s3, 56
  s_lshr_b32 s9, s5, 2
  s_add_u32 s8, s8, s9
  v_add_lshl_u32 v214, v8, s8, 7
  s_mov_b32 s73, 0
  s_mov_b32 s74, 0
  s_mov_b32 s70, 0
  s_mov_b32 m0, s72
  s_cmp_ge_u32 s71, 137
  s_cbranch_scc1 Lw1_32
  s_waitcnt vmcnt(1)
  s_branch Lw2_33
Lw1_32:
  s_waitcnt vmcnt(2)
Lw2_33:
  s_cmp_ge_u32 s4, 16
  s_cbranch_scc1 Lpj_34
  s_cmp_lg_u32 s3, 7
  s_cbranch_scc1 Lpj_34
  v_mov_b32 v8, 1
  s_mov_b64 exec, 1
  global_atomic_add v212, v8, s[42:43] offset:128
  s_mov_b64 exec, -1
Lpj_34:
Lpass_35:
  v_lshlrev_b32 v86, 16, v10
  v_lshlrev_b32 v87, 16, v11
  v_lshlrev_b32 v88, 16, v12
  v_lshlrev_b32 v89, 16, v13
  v_lshlrev_b32 v90, 16, v14
  v_lshlrev_b32 v91, 16, v15
  v_mul_f32 v86, s68, v86
  v_mul_f32 v87, s68, v87
  v_mul_f32 v88, s68, v88
  v_mul_f32 v89, s68, v89
  v_mul_f32 v92, 1069066811, v86
  v_mul_f32 v93, 1042479491, v87
  s_mov_b32 s8, 1042479491
  v_fma_f32 v94, v87, s8, -v93
  v_fmac_f32 v94, 836541576, v87
  v_pk_mul_f32 v[32:33], v[90:91], v[88:89] op_sel_hi:[0,1]
  v_pk_fma_f32 v[32:33], v[90:91], v[88:89], v[32:33] op_sel:[1,1,0] op_sel_hi:[1,0,1] neg_lo:[1,0,0]
  v_mul_f32 v48, 1098907648, v92
  v_mul_f32 v49, 1098907648, v93
  v_exp_f32 v48, v48
  v_fract_f32 v49, v49
  v_exp_f32 v52, v92
  v_fract_f32 v53, v93
  v_mul_f32 v98, 1132462080, v92
  v_mul_f32 v99, 1132462080, v93
  v_exp_f32 v98, v98
  v_fract_f32 v99, v99
  v_fmac_f32 v99, 1132462080, v94
  v_cos_f32 v50, v49
  v_sin_f32 v51, v49
  v_cos_f32 v54, v53
  v_sin_f32 v55, v53
  v_cos_f32 v100, v99
  v_sin_f32 v101, v99
  v_pk_mul_f32 v[28:29], v[50:51], v[48:49] op_sel_hi:[1,0]
  v_pk_mul_f32 v[20:21], v[54:55], v[52:53] op_sel_hi:[1,0]
  v_pk_mul_f32 v[30:31], v[100:101], v[98:99] op_sel_hi:[1,0]
  ds_write_addtid_b32 v9 offset:0
  v_pk_mul_f32 v[34:35], v[28:29], v[28:29] op_sel_hi:[0,1]
  v_pk_mul_f32 v[22:23], v[20:21], v[20:21] op_sel_hi:[0,1]
  v_pk_mul_f32 v[56:57], v[32:33], v[20:21] op_sel_hi:[0,1]
  v_pk_fma_f32 v[34:35], v[28:29], v[28:29], v[34:35] op_sel:[1,1,0] op_sel_hi:[1,0,1] neg_lo:[1,0,0]
  v_pk_fma_f32 v[22:23], v[20:21], v[20:21], v[22:23] op_sel:[1,1,0] op_sel_hi:[1,0,1] neg_lo:[1,0,0]
  v_pk_fma_f32 v[56:57], v[32:33], v[20:21], v[56:57] op_sel:[1,1,0] op_sel_hi:[1,0,1] neg_lo:[1,0,0]
  v_cvt_pk_bf16_f32 v104, v28, -v29
  ds_write_addtid_b32 v104 offset:288
  v_pk_mul_f32 v[36:37], v[34:35], v[28:29] op_sel_hi:[0,1]
  v_pk_mul_f32 v[38:39], v[34:35], v[34:35] op_sel_hi:[0,1]
  v_pk_mul_f32 v[24:25], v[22:23], v[22:23] op_sel_hi:[0,1]
  v_pk_mul_f32 v[58:59], v[32:33], v[22:23] op_sel_hi:[0,1]
  v_pk_mul_f32 v[60:61], v[56:57], v[22:23] op_sel_hi:[0,1]
  v_pk_fma_f32 v[36:37], v[34:35], v[28:29], v[36:37] op_sel:[1,1,0] op_sel_hi:[1,0,1] neg_lo:[1,0,0]
  v_pk_fma_f32 v[38:39], v[34:35], v[34:35], v[38:39] op_sel:[1,1,0] op_sel_hi:[1,0,1] neg_lo:[1,0,0]
  v_pk_fma_f32 v[24:25], v[22:23], v[22:23], v[24:25] op_sel:[1,1,0] op_sel_hi:[1,0,1] neg_lo:[1,0,0]
  v_pk_fma_f32 v[58:59], v[32:33], v[22:23], v[58:59] op_sel:[1,1,0] op_sel_hi:[1,0,1] neg_lo:[1,0,0]
  v_pk_fma_f32 v[60:61], v[56:57], v[22:23], v[60:61] op_sel:[1,1,0] op_sel_hi:[1,0,1] neg_lo:[1,0,0]
  v_cvt_pk_bf16_f32 v105, v34, -v35
  ds_write_addtid_b32 v105 offset:576
  v_pk_mul_f32 v[40:41], v[28:29], v[38:39] op_sel_hi:[0,1]
  v_pk_mul_f32 v[42:43], v[34:35], v[38:39] op_sel_hi:[0,1]
  v_pk_mul_f32 v[44:45], v[36:37], v[38:39] op_sel_hi:[0,1]
  v_pk_mul_f32 v[46:47], v[38:39], v[38:39] op_sel_hi:[0,1]
  v_pk_mul_f32 v[26:27], v[24:25], v[24:25] op_sel_hi:[0,1]
  v_pk_fma_f32 v[40:41], v[28:29], v[38:39], v[40:41] op_sel:[1,1,0] op_sel_hi:[1,0,1] neg_lo:[1,0,0]
  v_pk_fma_f32 v[42:43], v[34:35], v[38:39], v[42:43] op_sel:[1,1,0] op_sel_hi:[1,0,1] neg_lo:[1,0,0]
  v_pk_fma_f32 v[44:45], v[36:37], v[38:39], v[44:45] op_sel:[1,1,0] op_sel_hi:[1,0,1] neg_lo:[1,0,0]
  v_pk_fma_f32 v[46:47], v[38:39], v[38:39], v[46:47] op_sel:[1,1,0] op_sel_hi:[1,0,1] neg_lo:[1,0,0]
  v_pk_fma_f32 v[26:27], v[24:25], v[24:25], v[26:27] op_sel:[1,1,0] op_sel_hi:[1,0,1] neg_lo:[1,0,0]
  v_cvt_pk_bf16_f32 v106, v36, -v37
  ds_write_addtid_b32 v106 offset:864
  v_cvt_pk_bf16_f32 v107, v38, -v39
  ds_write_addtid_b32 v107 offset:1152
  v_pk_mul_f32 v[48:49], v[28:29], v[46:47] op_sel_hi:[0,1]
  v_pk_mul_f32 v[50:51], v[34:35], v[46:47] op_sel_hi:[0,1]
  v_pk_mul_f32 v[52:53], v[36:37], v[46:47] op_sel_hi:[0,1]
  v_pk_mul_f32 v[98:99], v[38:39], v[46:47] op_sel_hi:[0,1]
  v_pk_fma_f32 v[48:49], v[28:29], v[46:47], v[48:49] op_sel:[1,1,0] op_sel_hi:[1,0,1] neg_lo:[1,0,0]
  v_pk_fma_f32 v[50:51], v[34:35], v[46:47], v[50:51] op_sel:[1,1,0] op_sel_hi:[1,0,1] neg_lo:[1,0,0]
  v_pk_fma_f32 v[52:53], v[36:37], v[46:47], v[52:53] op_sel:[1,1,0] op_sel_hi:[1,0,1] neg_lo:[1,0,0]
  v_pk_fma_f32 v[98:99], v[38:39], v[46:47], v[98:99] op_sel:[1,1,0] op_sel_hi:[1,0,1] neg_lo:[1,0,0]
  v_cvt_pk_bf16_f32 v108, v40, -v41
  ds_write_addtid_b32 v108 offset:1440
  v_cvt_pk_bf16_f32 v109, v42, -v43
  ds_write_addtid_b32 v109 offset:1728
  v_cvt_pk_bf16_f32 v110, v44, -v45
  ds_write_addtid_b32 v110 offset:2016
  v_cvt_pk_bf16_f32 v111, v46, -v47
  ds_write_addtid_b32 v111 offset:2304
  v_pk_mul_f32 v[100:101], v[40:41], v[46:47] op_sel_hi:[0,1]
  v_pk_mul_f32 v[102:103], v[42:43], v[46:47] op_sel_hi:[0,1]
  v_pk_mul_f32 v[86:87], v[44:45], v[46:47] op_sel_hi:[0,1]
  v_pk_fma_f32 v[100:101], v[40:41], v[46:47], v[100:101] op_sel:[1,1,0] op_sel_hi:[1,0,1] neg_lo:[1,0,0]
  v_pk_fma_f32 v[102:103], v[42:43], v[46:47], v[102:103] op_sel:[1,1,0] op_sel_hi:[1,0,1] neg_lo:[1,0,0]
  v_pk_fma_f32 v[86:87], v[44:45], v[46:47], v[86:87] op_sel:[1,1,0] op_sel_hi:[1,0,1] neg_lo:[1,0,0]
  v_cvt_pk_bf16_f32 v104, v48, -v49
  ds_write_addtid_b32 v104 offset:2592
  v_cvt_pk_bf16_f32 v105, v50, -v51
  ds_write_addtid_b32 v105 offset:2880
  v_cvt_pk_bf16_f32 v106, v52, -v53
  ds_write_addtid_b32 v106 offset:3168
  v_cvt_pk_bf16_f32 v107, v98, -v99
  ds_write_addtid_b32 v107 offset:3456
  v_pk_mul_f32 v[62:63], v[32:33], v[24:25] op_sel_hi:[0,1]
  v_pk_mul_f32 v[64:65], v[56:57], v[24:25] op_sel_hi:[0,1]
  v_pk_mul_f32 v[66:67], v[58:59], v[24:25] op_sel_hi:[0,1]
  v_pk_mul_f32 v[68:69], v[60:61], v[24:25] op_sel_hi:[0,1]
  v_pk_fma_f32 v[62:63], v[32:33], v[24:25], v[62:63] op_sel:[1,1,0] op_sel_hi:[1,0,1] neg_lo:[1,0,0]
  v_pk_fma_f32 v[64:65], v[56:57], v[24:25], v[64:65] op_sel:[1,1,0] op_sel_hi:[1,0,1] neg_lo:[1,0,0]
  v_pk_fma_f32 v[66:67], v[58:59], v[24:25], v[66:67] op_sel:[1,1,0] op_sel_hi:[1,0,1] neg_lo:[1,0,0]
  v_pk_fma_f32 v[68:69], v[60:61], v[24:25], v[68:69] op_sel:[1,1,0] op_sel_hi:[1,0,1] neg_lo:[1,0,0]
  v_cvt_pk_bf16_f32 v108, v100, -v101
  ds_write_addtid_b32 v108 offset:3744
  v_cvt_pk_bf16_f32 v109, v102, -v103
  ds_write_addtid_b32 v109 offset:4032
  v_cvt_pk_bf16_f32 v110, v86, -v87
  ds_write_addtid_b32 v110 offset:4320
  ds_read_b128 v[112:115], v4 offset:0
  ds_read_b128 v[116:119], v4 offset:64
  ds_read_b128 v[120:123], v4 offset:128
  ds_read_b128 v[124:127], v4 offset:192
  v_pk_mul_f32 v[70:71], v[32:33], v[26:27] op_sel_hi:[0,1]
  v_pk_mul_f32 v[72:73], v[56:57], v[26:27] op_sel_hi:[0,1]
  v_pk_mul_f32 v[74:75], v[58:59], v[26:27] op_sel_hi:[0,1]
  v_pk_mul_f32 v[76:77], v[60:61], v[26:27] op_sel_hi:[0,1]
  v_pk_fma_f32 v[70:71], v[32:33], v[26:27], v[70:71] op_sel:[1,1,0] op_sel_hi:[1,0,1] neg_lo:[1,0,0]
  v_pk_fma_f32 v[72:73], v[56:57], v[26:27], v[72:73] op_sel:[1,1,0] op_sel_hi:[1,0,1] neg_lo:[1,0,0]
  v_pk_fma_f32 v[74:75], v[58:59], v[26:27], v[74:75] op_sel:[1,1,0] op_sel_hi:[1,0,1] neg_lo:[1,0,0]
  v_pk_fma_f32 v[76:77], v[60:61], v[26:27], v[76:77] op_sel:[1,1,0] op_sel_hi:[1,0,1] neg_lo:[1,0,0]
  v_cvt_pk_bf16_f32 v111, v32, v33
  ds_write_addtid_b32 v111 offset:0
  v_cvt_pk_bf16_f32 v104, v56, v57
  ds_write_addtid_b32 v104 offset:288
  v_cvt_pk_bf16_f32 v105, v58, v59
  ds_write_addtid_b32 v105 offset:576
  v_cvt_pk_bf16_f32 v106, v60, v61
  ds_write_addtid_b32 v106 offset:864
  v_pk_mul_f32 v[78:79], v[62:63], v[26:27] op_sel_hi:[0,1]
  v_pk_mul_f32 v[80:81], v[64:65], v[26:27] op_sel_hi:[0,1]
  v_pk_mul_f32 v[82:83], v[66:67], v[26:27] op_sel_hi:[0,1]
  v_pk_mul_f32 v[84:85], v[68:69], v[26:27] op_sel_hi:[0,1]
  v_pk_fma_f32 v[78:79], v[62:63], v[26:27], v[78:79] op_sel:[1,1,0] op_sel_hi:[1,0,1] neg_lo:[1,0,0]
  v_pk_fma_f32 v[80:81], v[64:65], v[26:27], v[80:81] op_sel:[1,1,0] op_sel_hi:[1,0,1] neg_lo:[1,0,0]
  v_pk_fma_f32 v[82:83], v[66:67], v[26:27], v[82:83] op_sel:[1,1,0] op_sel_hi:[1,0,1] neg_lo:[1,0,0]
  v_pk_fma_f32 v[84:85], v[68:69], v[26:27], v[84:85] op_sel:[1,1,0] op_sel_hi:[1,0,1] neg_lo:[1,0,0]
  v_cvt_pk_bf16_f32 v107, v62, v63
  ds_write_addtid_b32 v107 offset:1152
  v_cvt_pk_bf16_f32 v108, v64, v65
  ds_write_addtid_b32 v108 offset:1440
  v_cvt_pk_bf16_f32 v109, v66, v67
  ds_write_addtid_b32 v109 offset:1728
  v_cvt_pk_bf16_f32 v110, v68, v69
  ds_write_addtid_b32 v110 offset:2016
  v_cvt_pk_bf16_f32 v111, v70, v71
  ds_write_addtid_b32 v111 offset:2304
  v_cvt_pk_bf16_f32 v104, v72, v73
  ds_write_addtid_b32 v104 offset:2592
  v_cvt_pk_bf16_f32 v105, v74, v75
  ds_write_addtid_b32 v105 offset:2880
  v_cvt_pk_bf16_f32 v106, v76, v77
  ds_write_addtid_b32 v106 offset:3168
  v_cvt_pk_bf16_f32 v107, v78, v79
  ds_write_addtid_b32 v107 offset:3456
  v_cvt_pk_bf16_f32 v108, v80, v81
  ds_write_addtid_b32 v108 offset:3744
  v_cvt_pk_bf16_f32 v109, v82, v83
  ds_write_addtid_b32 v109 offset:4032
  v_cvt_pk_bf16_f32 v110, v84, v85
  ds_write_addtid_b32 v110 offset:4320
  ds_read_b128 v[128:131], v4 offset:0
  ds_read_b128 v[132:135], v4 offset:64
  ds_read_b128 v[136:139], v4 offset:128
  ds_read_b128 v[140:143], v4 offset:192
  s_cmp_eq_u32 s73, 0
  s_cbranch_scc1 Ltf_36
  s_cmp_lg_u32 s70, 0
  s_cbranch_scc1 Ltf_36
  s_waitcnt vmcnt(0)
  s_cmp_lg_u32 s74, 0
  s_cbranch_scc1 Lnsd_40
  s_cmp_lg_u32 s3, 0
  s_cbranch_scc1 Lnso_39
  v_readfirstlane_b32 s74, v213
  s_nop 0
  s_cmp_lg_u32 s74, 0
  s_cbranch_scc1 Lns0_38
  v_mov_b32 v212, 0
  s_mov_b32 s8, 0
Lnn_41:
  global_load_dword v213, v212, s[42:43] sc1
  s_waitcnt vmcnt(0)
  v_readfirstlane_b32 s74, v213
  s_add_u32 s8, s8, 1
  s_cmp_lg_u32 s74, 0
  s_cbranch_scc1 Lnd_42
  s_sleep 1
  s_cmp_lt_u32 s8, 200000
  s_cbranch_scc1 Lnn_41
Lnd_42:
Lns0_38:
  v_mov_b32 v213, s74
  ds_write_b32 v211, v213
  s_branch Lnsd_40
Lnso_39:
  s_mov_b32 s8, 0
Lnss_43:
  ds_read_b32 v213, v211
  s_add_u32 s8, s8, 1
  s_waitcnt lgkmcnt(0)
  v_readfirstlane_b32 s74, v213
  s_cmp_ge_u32 s8, 1600000
  s_cselect_b32 s74, 1, s74
  s_cmp_eq_u32 s74, 0
  s_cbranch_scc1 Lnss_43
Lnsd_40:
  v_cmp_ne_u32 vcc, s74, v215
  s_nop 0
  s_cmp_lg_u64 vcc, 0
  s_cbranch_scc1 Lre_37
  v_lshlrev_b32 v8, 4, v1
  s_lshl_b32 s8, s5, 14
  s_lshl_b32 s11, s3, 11
  s_add_u32 s8, s8, s11
  s_add_u32 m0, s11, 121984
  s_add_u32 s10, s8, 0
  buffer_load_dwordx4 v8, s[56:59], s10 offen sc1 lds
  s_add_u32 m0, s11, 123008
  s_add_u32 s10, s8, 1024
  buffer_load_dwordx4 v8, s[56:59], s10 offen sc1 lds
  s_mov_b32 m0, s72
  s_mov_b32 s70, 1
  s_branch Ltf_36
Lre_37:
  s_mov_b32 s10, 4456448
  buffer_load_dword v215, v214, s[56:59], s10 offen sc1
Ltf_36:
  v_pk_mul_f32 v[34:35], v[32:33], v[30:31] op_sel_hi:[0,1]
  v_pk_mul_f32 v[36:37], v[58:59], v[30:31] op_sel_hi:[0,1]
  v_pk_mul_f32 v[38:39], v[62:63], v[30:31] op_sel_hi:[0,1]
  v_pk_mul_f32 v[40:41], v[66:67], v[30:31] op_sel_hi:[0,1]
  v_pk_fma_f32 v[34:35], v[32:33], v[30:31], v[34:35] op_sel:[1,1,0] op_sel_hi:[1,0,1] neg_lo:[1,0,0]
  v_pk_fma_f32 v[36:37], v[58:59], v[30:31], v[36:37] op_sel:[1,1,0] op_sel_hi:[1,0,1] neg_lo:[1,0,0]
  v_pk_fma_f32 v[38:39], v[62:63], v[30:31], v[38:39] op_sel:[1,1,0] op_sel_hi:[1,0,1] neg_lo:[1,0,0]
  v_pk_fma_f32 v[40:41], v[66:67], v[30:31], v[40:41] op_sel:[1,1,0] op_sel_hi:[1,0,1] neg_lo:[1,0,0]
  v_pk_mul_f32 v[42:43], v[70:71], v[30:31] op_sel_hi:[0,1]
  v_pk_mul_f32 v[44:45], v[74:75], v[30:31] op_sel_hi:[0,1]
  v_pk_mul_f32 v[46:47], v[78:79], v[30:31] op_sel_hi:[0,1]
  v_pk_mul_f32 v[48:49], v[82:83], v[30:31] op_sel_hi:[0,1]
  v_pk_fma_f32 v[42:43], v[70:71], v[30:31], v[42:43] op_sel:[1,1,0] op_sel_hi:[1,0,1] neg_lo:[1,0,0]
  v_pk_fma_f32 v[44:45], v[74:75], v[30:31], v[44:45] op_sel:[1,1,0] op_sel_hi:[1,0,1] neg_lo:[1,0,0]
  v_pk_fma_f32 v[46:47], v[78:79], v[30:31], v[46:47] op_sel:[1,1,0] op_sel_hi:[1,0,1] neg_lo:[1,0,0]
  v_pk_fma_f32 v[48:49], v[82:83], v[30:31], v[48:49] op_sel:[1,1,0] op_sel_hi:[1,0,1] neg_lo:[1,0,0]
  v_pk_mul_f32 v[86:87], v[34:35], v[30:31] op_sel_hi:[0,1]
  v_pk_mul_f32 v[88:89], v[38:39], v[30:31] op_sel_hi:[0,1]
  v_pk_mul_f32 v[90:91], v[42:43], v[30:31] op_sel_hi:[0,1]
  v_pk_mul_f32 v[92:93], v[46:47], v[30:31] op_sel_hi:[0,1]
  v_pk_fma_f32 v[86:87], v[34:35], v[30:31], v[86:87] op_sel:[1,1,0] op_sel_hi:[1,0,1] neg_lo:[1,0,0]
  v_pk_fma_f32 v[88:89], v[38:39], v[30:31], v[88:89] op_sel:[1,1,0] op_sel_hi:[1,0,1] neg_lo:[1,0,0]
  v_pk_fma_f32 v[90:91], v[42:43], v[30:31], v[90:91] op_sel:[1,1,0] op_sel_hi:[1,0,1] neg_lo:[1,0,0]
  v_pk_fma_f32 v[92:93], v[46:47], v[30:31], v[92:93] op_sel:[1,1,0] op_sel_hi:[1,0,1] neg_lo:[1,0,0]
  v_pk_mul_f32 v[94:95], v[86:87], v[30:31] op_sel_hi:[0,1]
  v_pk_mul_f32 v[96:97], v[88:89], v[30:31] op_sel_hi:[0,1]
  v_pk_mul_f32 v[98:99], v[90:91], v[30:31] op_sel_hi:[0,1]
  v_pk_mul_f32 v[100:101], v[92:93], v[30:31] op_sel_hi:[0,1]
  v_pk_fma_f32 v[94:95], v[86:87], v[30:31], v[94:95] op_sel:[1,1,0] op_sel_hi:[1,0,1] neg_lo:[1,0,0]
  v_pk_fma_f32 v[96:97], v[88:89], v[30:31], v[96:97] op_sel:[1,1,0] op_sel_hi:[1,0,1] neg_lo:[1,0,0]
  v_pk_fma_f32 v[98:99], v[90:91], v[30:31], v[98:99] op_sel:[1,1,0] op_sel_hi:[1,0,1] neg_lo:[1,0,0]
  v_pk_fma_f32 v[100:101], v[92:93], v[30:31], v[100:101] op_sel:[1,1,0] op_sel_hi:[1,0,1] neg_lo:[1,0,0]
  s_waitcnt lgkmcnt(0)
  v_mfma_f32_16x16x32_bf16 v[160:163], v[128:131], v[112:115], v[160:163]
  v_cvt_pk_bf16_f32 v111, v34, v35
  ds_write_addtid_b32 v111 offset:0
  v_cvt_pk_bf16_f32 v104, v36, v37
  ds_write_addtid_b32 v104 offset:288
  v_cvt_pk_bf16_f32 v105, v38, v39
  ds_write_addtid_b32 v105 offset:576
  v_cvt_pk_bf16_f32 v106, v40, v41
  ds_write_addtid_b32 v106 offset:864
  v_mfma_f32_16x16x32_bf16 v[160:163], v[132:135], v[116:119], v[160:163]
  v_cvt_pk_bf16_f32 v107, v42, v43
  ds_write_addtid_b32 v107 offset:1152
  v_cvt_pk_bf16_f32 v108, v44, v45
  ds_write_addtid_b32 v108 offset:1440
  v_cvt_pk_bf16_f32 v109, v46, v47
  ds_write_addtid_b32 v109 offset:1728
  v_cvt_pk_bf16_f32 v110, v48, v49
  ds_write_addtid_b32 v110 offset:2016
  v_mfma_f32_16x16x32_bf16 v[160:163], v[136:139], v[120:123], v[160:163]
  v_cvt_pk_bf16_f32 v111, v86, v87
  ds_write_addtid_b32 v111 offset:2304
  v_cvt_pk_bf16_f32 v104, v88, v89
  ds_write_addtid_b32 v104 offset:2592
  v_cvt_pk_bf16_f32 v105, v90, v91
  ds_write_addtid_b32 v105 offset:2880
  v_cvt_pk_bf16_f32 v106, v92, v93
  ds_write_addtid_b32 v106 offset:3168
  v_mfma_f32_16x16x32_bf16 v[160:163], v[140:143], v[124:127], v[160:163]
  v_cvt_pk_bf16_f32 v107, v94, v95
  ds_write_addtid_b32 v107 offset:3456
  v_cvt_pk_bf16_f32 v108, v96, v97
  ds_write_addtid_b32 v108 offset:3744
  v_cvt_pk_bf16_f32 v109, v98, v99
  ds_write_addtid_b32 v109 offset:4032
  v_cvt_pk_bf16_f32 v110, v100, v101
  ds_write_addtid_b32 v110 offset:4320
  ds_read_b128 v[144:147], v4 offset:0
  ds_read_b128 v[148:151], v4 offset:64
  ds_read_b128 v[152:155], v4 offset:128
  ds_read_b128 v[156:159], v4 offset:192
  v_pk_mul_f32 v[56:57], v[94:95], v[30:31] op_sel_hi:[0,1]
  v_pk_mul_f32 v[58:59], v[98:99], v[30:31] op_sel_hi:[0,1]
  v_pk_fma_f32 v[56:57], v[94:95], v[30:31], v[56:57] op_sel:[1,1,0] op_sel_hi:[1,0,1] neg_lo:[1,0,0]
  v_pk_fma_f32 v[58:59], v[98:99], v[30:31], v[58:59] op_sel:[1,1,0] op_sel_hi:[1,0,1] neg_lo:[1,0,0]
  v_pk_mul_f32 v[60:61], v[56:57], v[30:31] op_sel_hi:[0,1]
  v_pk_mul_f32 v[62:63], v[58:59], v[30:31] op_sel_hi:[0,1]
  v_pk_fma_f32 v[60:61], v[56:57], v[30:31], v[60:61] op_sel:[1,1,0] op_sel_hi:[1,0,1] neg_lo:[1,0,0]
  v_pk_fma_f32 v[62:63], v[58:59], v[30:31], v[62:63] op_sel:[1,1,0] op_sel_hi:[1,0,1] neg_lo:[1,0,0]
  v_pk_mul_f32 v[64:65], v[60:61], v[30:31] op_sel_hi:[0,1]
  v_pk_mul_f32 v[66:67], v[62:63], v[30:31] op_sel_hi:[0,1]
  v_pk_fma_f32 v[64:65], v[60:61], v[30:31], v[64:65] op_sel:[1,1,0] op_sel_hi:[1,0,1] neg_lo:[1,0,0]
  v_pk_fma_f32 v[66:67], v[62:63], v[30:31], v[66:67] op_sel:[1,1,0] op_sel_hi:[1,0,1] neg_lo:[1,0,0]
  v_pk_mul_f32 v[68:69], v[64:65], v[30:31] op_sel_hi:[0,1]
  v_pk_mul_f32 v[70:71], v[66:67], v[30:31] op_sel_hi:[0,1]
  v_pk_fma_f32 v[68:69], v[64:65], v[30:31], v[68:69] op_sel:[1,1,0] op_sel_hi:[1,0,1] neg_lo:[1,0,0]
  v_pk_fma_f32 v[70:71], v[66:67], v[30:31], v[70:71] op_sel:[1,1,0] op_sel_hi:[1,0,1] neg_lo:[1,0,0]
  v_pk_mul_f32 v[72:73], v[68:69], v[30:31] op_sel_hi:[0,1]
  v_pk_fma_f32 v[72:73], v[68:69], v[30:31], v[72:73] op_sel:[1,1,0] op_sel_hi:[1,0,1] neg_lo:[1,0,0]
  s_waitcnt lgkmcnt(0)
  v_mfma_f32_16x16x32_bf16 v[164:167], v[144:147], v[112:115], v[164:167]
  v_cvt_pk_bf16_f32 v111, v56, v57
  ds_write_addtid_b32 v111 offset:0
  v_cvt_pk_bf16_f32 v104, v64, v65
  ds_write_addtid_b32 v104 offset:1152
  v_cvt_pk_bf16_f32 v105, v72, v73
  ds_write_addtid_b32 v105 offset:2304
  v_mfma_f32_16x16x32_bf16 v[164:167], v[148:151], v[116:119], v[164:167]
  v_cvt_pk_bf16_f32 v106, v58, v59
  ds_write_addtid_b32 v106 offset:288
  v_cvt_pk_bf16_f32 v107, v66, v67
  ds_write_addtid_b32 v107 offset:1440
  v_mfma_f32_16x16x32_bf16 v[164:167], v[152:155], v[120:123], v[164:167]
  v_cvt_pk_bf16_f32 v108, v60, v61
  ds_write_addtid_b32 v108 offset:576
  v_cvt_pk_bf16_f32 v109, v68, v69
  ds_write_addtid_b32 v109 offset:1728
  v_mfma_f32_16x16x32_bf16 v[164:167], v[156:159], v[124:127], v[164:167]
  v_cvt_pk_bf16_f32 v110, v62, v63
  ds_write_addtid_b32 v110 offset:864
  v_cvt_pk_bf16_f32 v111, v70, v71
  ds_write_addtid_b32 v111 offset:2016
  ds_read_b128 v[128:131], v4 offset:0
  ds_read_b128 v[132:135], v4 offset:64
  ds_read_b128 v[136:139], v4 offset:128
  ds_read_b128 v[140:143], v4 offset:192
  v_lshrrev_b32 v10, 16, v10
  v_lshrrev_b32 v11, 16, v11
  v_lshrrev_b32 v12, 16, v12
  v_lshrrev_b32 v13, 16, v13
  v_lshrrev_b32 v14, 16, v14
  v_lshrrev_b32 v15, 16, v15
  s_nop 1
  s_cmp_lg_u32 s73, 0
  s_cbranch_scc1 Lraw_44
  v_mov_b32 v6, 0
  v_mov_b32 v7, 0
  s_mul_i32 s9, s3, 16640
  s_add_u32 s9, s9, 53248
  s_cmp_lt_u32 s3, 4
  s_cselect_b32 s9, s9, 121856
  v_lshl_add_u32 v8, v2, 3, s9
  ds_write_b64 v8, v[6:7]
  s_mov_b32 s9, 4456448
  buffer_load_dword v215, v214, s[56:59], s9 offen sc1
  s_or_b32 s8, s74, s3
  s_cmp_lg_u32 s8, 0
  s_cbranch_scc1 Lpn_45
  global_load_dword v213, v212, s[42:43] sc1
Lpn_45:
Lraw_44:
  s_waitcnt lgkmcnt(0)
  v_mfma_f32_16x16x32_bf16 v[168:171], v[128:131], v[112:115], v[168:171]
  v_mfma_f32_16x16x32_bf16 v[168:171], v[132:135], v[116:119], v[168:171]
  v_mfma_f32_16x16x32_bf16 v[168:171], v[136:139], v[120:123], v[168:171]
  v_mfma_f32_16x16x32_bf16 v[168:171], v[140:143], v[124:127], v[168:171]
  s_add_u32 s73, s73, 1
  s_cmp_lt_u32 s73, 2
  s_cbranch_scc1 Lpass_35
  s_cmp_lg_u32 s70, 0
  s_cbranch_scc1 Lp2_46
  s_waitcnt vmcnt(0)
  s_cmp_lg_u32 s74, 0
  s_cbranch_scc1 Lnsd_50
  s_cmp_lg_u32 s3, 0
  s_cbranch_scc1 Lnso_49
  v_readfirstlane_b32 s74, v213
  s_nop 0
  s_cmp_lg_u32 s74, 0
  s_cbranch_scc1 Lns0_48
  v_mov_b32 v212, 0
  s_mov_b32 s8, 0
Lnn_51:
  global_load_dword v213, v212, s[42:43] sc1
  s_waitcnt vmcnt(0)
  v_readfirstlane_b32 s74, v213
  s_add_u32 s8, s8, 1
  s_cmp_lg_u32 s74, 0
  s_cbranch_scc1 Lnd_52
  s_sleep 1
  s_cmp_lt_u32 s8, 200000
  s_cbranch_scc1 Lnn_51
Lnd_52:
Lns0_48:
  v_mov_b32 v213, s74
  ds_write_b32 v211, v213
  s_branch Lnsd_50
Lnso_49:
  s_mov_b32 s8, 0
Lnss_53:
  ds_read_b32 v213, v211
  s_add_u32 s8, s8, 1
  s_waitcnt lgkmcnt(0)
  v_readfirstlane_b32 s74, v213
  s_cmp_ge_u32 s8, 1600000
  s_cselect_b32 s74, 1, s74
  s_cmp_eq_u32 s74, 0
  s_cbranch_scc1 Lnss_53
Lnsd_50:
  v_cmp_ne_u32 vcc, s74, v215
  s_nop 0
  s_cmp_lg_u64 vcc, 0
  s_cbranch_scc1 Lre_47
  v_lshlrev_b32 v8, 4, v1
  s_lshl_b32 s8, s5, 14
  s_lshl_b32 s11, s3, 11
  s_add_u32 s8, s8, s11
  s_add_u32 m0, s11, 121984
  s_add_u32 s10, s8, 0
  buffer_load_dwordx4 v8, s[56:59], s10 offen sc1 lds
  s_add_u32 m0, s11, 123008
  s_add_u32 s10, s8, 1024
  buffer_load_dwordx4 v8, s[56:59], s10 offen sc1 lds
  s_mov_b32 m0, s72
  s_mov_b32 s70, 1
  s_branch Lp2_46
Lre_47:
  s_mov_b32 s10, 4456448
  buffer_load_dword v215, v214, s[56:59], s10 offen sc1
Lp2_46:
  v_lshl_add_u32 v5, v1, 4, s72
  s_xor_b32 s8, s3, 1
  s_mul_i32 s8, s8, 4608
  v_lshl_add_u32 v6, v1, 4, s8
  s_mul_i32 s9, s14, 4608
  s_add_u32 s9, s9, 103936
  v_lshlrev_b32 v7, 5, v2
  v_sub_u32 v52, 15, v2
  v_and_b32 v53, 3, v52
  v_lshrrev_b32 v52, 2, v52
  v_lshl_add_u32 v52, v3, 1, v52
  v_mul_u32_u24 v54, 16640, v53
  v_xor_b32 v53, s14, v53
  v_lshl_add_u32 v54, v53, 4, v54
  s_lshl_b32 s8, s15, 10
  s_sub_u32 s8, 38400, s8
  v_add_u32 v54, s8, v54
  v_lshrrev_b32 v53, 1, v52
  v_lshl_add_u32 v55, v53, 6, v54
  v_and_b32 v53, 1, v52
  v_lshl_add_u32 v60, v53, 3, v55
  v_add_u32 v52, 1, v52
  v_lshrrev_b32 v53, 1, v52
  v_lshl_add_u32 v55, v53, 6, v54
  v_and_b32 v53, 1, v52
  v_lshl_add_u32 v61, v53, 3, v55
  v_lshlrev_b32 v62, 5, v2
  v_lshl_add_u32 v62, v3, 4, v62
  s_lshl_b32 s8, s15, 8
  s_sub_u32 s8, s9, s8
  s_sub_u32 s8, s8, 96
  v_add_u32 v62, s8, v62
  v_lshlrev_b32 v52, 2, v2
  v_add_u32 v52, v52, v3
  v_sub_u32 v52, 63, v52
  v_lshrrev_b32 v53, 1, v52
  v_lshlrev_b32 v53, 6, v53
  v_and_b32 v52, 1, v52
  v_lshl_add_u32 v53, v52, 3, v53
  s_lshl_b32 s8, s14, 4
  s_add_u32 s8, s8, 36864
  v_add_u32 v63, s8, v53
  v_mov_b32 v64, 0
  v_mov_b32 v65, 0
  v_mov_b32 v66, 0
  v_mov_b32 v67, 0
  v_mov_b32 v68, 0
  v_mov_b32 v69, 0
  v_mov_b32 v70, 0
  v_mov_b32 v71, 0
  v_mov_b32 v72, 0
  v_mov_b32 v73, 0
  v_mov_b32 v74, 0
  v_mov_b32 v75, 0
  v_mov_b32 v76, 0
  v_mov_b32 v77, 0
  v_mov_b32 v78, 0
  v_mov_b32 v79, 0
  v_mov_b32 v80, 0
  v_mov_b32 v81, 0
  v_mov_b32 v82, 0
  v_mov_b32 v83, 0
  v_mov_b32 v84, 0
  v_mov_b32 v85, 0
  v_mov_b32 v86, 0
  v_mov_b32 v87, 0
  v_mov_b32 v88, 0
  v_mov_b32 v89, 0
  v_mov_b32 v90, 0
  v_mov_b32 v91, 0
  v_mov_b32 v92, 0
  v_mov_b32 v93, 0
  v_mov_b32 v94, 0
  v_mov_b32 v95, 0
  s_nop 1
  s_cmp_lg_u32 s15, 0
  s_cbranch_scc1 Lh1_54
  ds_write_b128 v5, v[164:167]
  ds_write_b128 v5, v[168:171] offset:1024
  v_lshl_add_u32 v7, v3, 3, v7
  v_add_u32 v7, s9, v7
  s_sub_u32 s8, s9, 512
  v_lshl_add_u32 v8, v1, 3, s8
  v_mov_b32 v26, 0
  v_mov_b32 v27, 0
  s_waitcnt lgkmcnt(0)
  s_barrier
  ds_read_b128 v[20:23], v6
  ds_write_b64 v8, v[26:27]
  s_waitcnt lgkmcnt(1)
  v_pk_add_f32 v[20:21], v[20:21], v[160:161]
  v_pk_add_f32 v[22:23], v[22:23], v[162:163]
  v_cvt_pk_bf16_f32 v24, v20, v21
  v_cvt_pk_bf16_f32 v25, v22, v23
  ds_write_b64 v7, v[24:25]
  s_branch Lkj_55
Lh1_54:
  ds_write_b128 v5, v[160:163]
  v_add_u32 v7, s9, v7
  v_lshl_add_u32 v8, v3, 10, v7
  v_lshl_add_u32 v28, v3, 9, v7
  v_subrev_u32 v28, 4, v28
  v_lshl_add_u32 v29, v3, 4, v7
  s_waitcnt lgkmcnt(0)
  s_barrier
  ds_read_b128 v[24:27], v6 offset:1024
  ds_read_b128 v[20:23], v6
  s_waitcnt lgkmcnt(1)
  v_pk_add_f32 v[24:25], v[24:25], v[168:169]
  v_pk_add_f32 v[26:27], v[26:27], v[170:171]
  v_cvt_pk_bf16_f32 v30, v24, v24
  v_cvt_pk_bf16_f32 v31, v24, v24
  v_cvt_pk_bf16_f32 v32, v24, v25
  v_cvt_pk_bf16_f32 v33, v25, v25
  v_cvt_pk_bf16_f32 v34, v25, v25
  v_cvt_pk_bf16_f32 v35, v25, v25
  v_cvt_pk_bf16_f32 v36, v26, v26
  v_cvt_pk_bf16_f32 v37, v26, v26
  v_cvt_pk_bf16_f32 v38, v26, v27
  v_cvt_pk_bf16_f32 v39, v27, v27
  v_cvt_pk_bf16_f32 v40, v27, v27
  v_cvt_pk_bf16_f32 v41, v27, v27
  s_mov_b32 exec_hi, 1
  ds_write_b64 v8, v[30:31] offset:2040
  s_mov_b32 exec_hi, 0
  ds_write_b64 v8, v[30:31] offset:2048
  ds_write_b64 v8, v[32:33] offset:2056
  ds_write_b64 v8, v[34:35] offset:2064
  ds_write_b64 v8, v[36:37] offset:2552
  ds_write_b64 v8, v[36:37] offset:2560
  ds_write_b64 v8, v[38:39] offset:2568
  ds_write_b64 v8, v[40:41] offset:2576
  s_mov_b32 exec_hi, -1
  s_waitcnt lgkmcnt(8)
  v_pk_add_f32 v[20:21], v[20:21], v[164:165]
  v_pk_add_f32 v[22:23], v[22:23], v[166:167]
  v_cvt_pk_bf16_f32 v42, v20, v20
  v_cvt_pk_bf16_f32 v43, v20, v21
  v_cvt_pk_bf16_f32 v44, v21, v21
  v_cvt_pk_bf16_f32 v45, v22, v22
  v_cvt_pk_bf16_f32 v46, v22, v22
  v_cvt_pk_bf16_f32 v47, v22, v23
  v_cvt_pk_bf16_f32 v48, v23, v23
  v_cvt_pk_bf16_f32 v50, v20, v20
  v_cvt_pk_bf16_f32 v51, v21, v22
  s_mov_b32 exec_lo, 0
  ds_write_b32 v28, v42
  ds_write_b64 v28, v[42:43] offset:4
  ds_write_b64 v28, v[44:45] offset:12
  ds_write_b64 v28, v[46:47] offset:20
  ds_write_b32 v28, v48 offset:28
  s_mov_b32 exec_lo, -2
  s_mov_b32 exec_hi, 0
  ds_write_b16 v29, v50 offset:510
  s_mov_b32 exec_lo, -1
  ds_write_b64 v29, v[50:51] offset:512
  ds_write_b32 v29, v45 offset:520
  ds_write_b16 v29, v48 offset:524
  s_mov_b64 exec, -1
Lkj_55:
  v_lshlrev_b32 v5, 8, v3
  v_and_b32 v6, 3, v1
  v_lshl_add_u32 v5, v6, 6, v5
  v_bfe_u32 v7, v1, 2, 2
  v_lshl_add_u32 v5, v7, 3, v5
  s_lshl_b32 s8, s3, 11
  s_sub_u32 s8, 137280, s8
  v_sub_u32 v5, s8, v5
  v_lshrrev_b32 v7, 2, v1
  v_lshlrev_b32 v7, 6, v7
  s_lshl_b32 s8, s3, 11
  s_add_u32 s8, s8, 36864
  v_add_u32 v7, s8, v7
  v_xor_b32 v8, 0, v6
  v_lshl_add_u32 v172, v8, 4, v7
  v_xor_b32 v8, 1, v6
  v_lshl_add_u32 v173, v8, 4, v7
  v_xor_b32 v8, 2, v6
  v_lshl_add_u32 v174, v8, 4, v7
  v_xor_b32 v8, 3, v6
  v_lshl_add_u32 v175, v8, 4, v7
  s_cmp_lg_u32 s70, 0
  s_cbranch_scc1 Lp3_56
  s_waitcnt vmcnt(0)
  v_cmp_ne_u32 vcc, s74, v215
  s_nop 0
  s_cmp_eq_u64 vcc, 0
  s_cbranch_scc1 Lp3k_57
  s_mov_b32 s10, 4456448
  s_mov_b32 s8, 0
Lpl_58:
  buffer_load_dword v215, v214, s[56:59], s10 offen sc1
  s_waitcnt vmcnt(0)
  v_cmp_ne_u32 vcc, s74, v215
  s_add_u32 s8, s8, 1
  s_cmp_eq_u64 vcc, 0
  s_cbranch_scc1 Lpd_59
  s_cmp_lt_u32 s8, 200000
  s_cbranch_scc1 Lpl_58
Lpd_59:
Lp3k_57:
  v_lshlrev_b32 v8, 4, v1
  s_lshl_b32 s8, s5, 14
  s_lshl_b32 s11, s3, 11
  s_add_u32 s8, s8, s11
  s_add_u32 m0, s11, 121984
  s_add_u32 s10, s8, 0
  buffer_load_dwordx4 v8, s[56:59], s10 offen sc1 lds
  s_add_u32 m0, s11, 123008
  s_add_u32 s10, s8, 1024
  buffer_load_dwordx4 v8, s[56:59], s10 offen sc1 lds
  s_mov_b32 m0, s72
  s_mov_b32 s70, 1
Lp3_56:
  s_waitcnt vmcnt(0)
  s_barrier
  ds_read_b64_tr_b16 v[180:181], v5 offset:1080
  ds_read_b64_tr_b16 v[182:183], v5 offset:1048
  ds_read_b64_tr_b16 v[184:185], v5 offset:1072
  ds_read_b64_tr_b16 v[186:187], v5 offset:1040
  ds_read_b64_tr_b16 v[188:189], v5 offset:1064
  ds_read_b64_tr_b16 v[190:191], v5 offset:1032
  ds_read_b64_tr_b16 v[192:193], v5 offset:1056
  ds_read_b64_tr_b16 v[194:195], v5 offset:1024
  ds_read_b64_tr_b16 v[196:197], v5 offset:56
  ds_read_b64_tr_b16 v[198:199], v5 offset:24
  ds_read_b64_tr_b16 v[200:201], v5 offset:48
  ds_read_b64_tr_b16 v[202:203], v5 offset:16
  ds_read_b64_tr_b16 v[204:205], v5 offset:40
  ds_read_b64_tr_b16 v[206:207], v5 offset:8
  ds_read_b64_tr_b16 v[208:209], v5 offset:32
  ds_read_b64_tr_b16 v[210:211], v5 offset:0
  s_waitcnt lgkmcnt(14)
  ds_write_b128 v172, v[180:183] offset:0
  s_waitcnt lgkmcnt(13)
  ds_write_b128 v173, v[184:187] offset:16640
  s_waitcnt lgkmcnt(12)
  ds_write_b128 v174, v[188:191] offset:33280
  s_waitcnt lgkmcnt(11)
  ds_write_b128 v175, v[192:195] offset:49920
  s_waitcnt lgkmcnt(10)
  ds_write_b128 v172, v[196:199] offset:1024
  s_waitcnt lgkmcnt(9)
  ds_write_b128 v173, v[200:203] offset:17664
  s_waitcnt lgkmcnt(8)
  ds_write_b128 v174, v[204:207] offset:34304
  s_waitcnt lgkmcnt(7)
  ds_write_b128 v175, v[208:211] offset:50944
  s_mov_b32 s73, 0
  s_waitcnt lgkmcnt(0)
  s_barrier
  ds_read_b64 v[96:97], v60 offset:14592
  ds_read_b64 v[98:99], v61 offset:14592
  ds_read_b128 v[128:131], v62 offset:64
  ds_read_b64 v[100:101], v60 offset:12544
  ds_read_b64 v[102:103], v61 offset:12544
  ds_read_b128 v[132:135], v62 offset:576
  ds_read_b64 v[104:105], v60 offset:10496
  ds_read_b64 v[106:107], v61 offset:10496
  ds_read_b128 v[136:139], v62 offset:1088
  ds_read_b64 v[108:109], v60 offset:8448
  ds_read_b64 v[110:111], v61 offset:8448
  ds_read_b128 v[140:143], v62 offset:1600
  ds_read_b64 v[112:113], v60 offset:6400
  ds_read_b64 v[114:115], v61 offset:6400
  ds_read_b128 v[144:147], v62 offset:2112
  ds_read_b64 v[116:117], v60 offset:4352
  ds_read_b64 v[118:119], v61 offset:4352
  ds_read_b128 v[148:151], v62 offset:2624
  ds_read_b64 v[120:121], v60 offset:2304
  ds_read_b64 v[122:123], v61 offset:2304
  ds_read_b128 v[152:155], v62 offset:3136
  ds_read_b64 v[124:125], v60 offset:256
  ds_read_b64 v[126:127], v61 offset:256
  ds_read_b128 v[156:159], v62 offset:3648
  s_waitcnt lgkmcnt(15)
  v_mfma_f32_16x16x32_bf16 v[64:67], v[96:99], v[128:131], v[64:67]
  v_mfma_f32_16x16x32_bf16 v[68:71], v[96:99], v[132:135], v[68:71]
  v_mfma_f32_16x16x32_bf16 v[68:71], v[100:103], v[128:131], v[68:71]
  v_mfma_f32_16x16x32_bf16 v[72:75], v[100:103], v[132:135], v[72:75]
  v_mfma_f32_16x16x32_bf16 v[72:75], v[96:99], v[136:139], v[72:75]
  ds_read_b64 v[160:161], v60 offset:14336
  v_mfma_f32_16x16x32_bf16 v[72:75], v[104:107], v[128:131], v[72:75]
  ds_read_b64 v[162:163], v61 offset:14336
  v_mfma_f32_16x16x32_bf16 v[76:79], v[100:103], v[136:139], v[76:79]
  ds_read_b128 v[192:195], v62 offset:0
  v_mfma_f32_16x16x32_bf16 v[76:79], v[104:107], v[132:135], v[76:79]
  ds_read_b64 v[164:165], v60 offset:12288
  v_mfma_f32_16x16x32_bf16 v[80:83], v[104:107], v[136:139], v[80:83]
  ds_read_b64 v[166:167], v61 offset:12288
  s_waitcnt lgkmcnt(15)
  v_mfma_f32_16x16x32_bf16 v[76:79], v[96:99], v[140:143], v[76:79]
  ds_read_b128 v[196:199], v62 offset:512
  v_mfma_f32_16x16x32_bf16 v[76:79], v[108:111], v[128:131], v[76:79]
  ds_read_b64 v[168:169], v60 offset:10240
  v_mfma_f32_16x16x32_bf16 v[80:83], v[100:103], v[140:143], v[80:83]
  ds_read_b64 v[170:171], v61 offset:10240
  v_mfma_f32_16x16x32_bf16 v[80:83], v[108:111], v[132:135], v[80:83]
  ds_read_b128 v[200:203], v62 offset:1024
  v_mfma_f32_16x16x32_bf16 v[84:87], v[104:107], v[140:143], v[84:87]
  ds_read_b64 v[172:173], v60 offset:8192
  v_mfma_f32_16x16x32_bf16 v[84:87], v[108:111], v[136:139], v[84:87]
  ds_read_b64 v[174:175], v61 offset:8192
  v_mfma_f32_16x16x32_bf16 v[88:91], v[108:111], v[140:143], v[88:91]
  ds_read_b128 v[204:207], v62 offset:1536
  s_waitcnt lgkmcnt(15)
  v_mfma_f32_16x16x32_bf16 v[80:83], v[96:99], v[144:147], v[80:83]
  ds_read_b64 v[176:177], v60 offset:6144
  v_mfma_f32_16x16x32_bf16 v[80:83], v[112:115], v[128:131], v[80:83]
  ds_read_b64 v[178:179], v61 offset:6144
  v_mfma_f32_16x16x32_bf16 v[84:87], v[100:103], v[144:147], v[84:87]
  ds_read_b128 v[208:211], v62 offset:2048
  v_mfma_f32_16x16x32_bf16 v[84:87], v[112:115], v[132:135], v[84:87]
  ds_read_b64 v[180:181], v60 offset:4096
  v_mfma_f32_16x16x32_bf16 v[88:91], v[104:107], v[144:147], v[88:91]
  ds_read_b64 v[182:183], v61 offset:4096
  v_mfma_f32_16x16x32_bf16 v[88:91], v[112:115], v[136:139], v[88:91]
  ds_read_b128 v[212:215], v62 offset:2560
  v_mfma_f32_16x16x32_bf16 v[92:95], v[108:111], v[144:147], v[92:95]
  ds_read_b64 v[184:185], v60 offset:2048
  v_mfma_f32_16x16x32_bf16 v[92:95], v[112:115], v[140:143], v[92:95]
  ds_read_b64 v[186:187], v61 offset:2048
  v_mfma_f32_16x16x32_bf16 v[84:87], v[96:99], v[148:151], v[84:87]
  ds_read_b128 v[216:219], v62 offset:3072
  v_mfma_f32_16x16x32_bf16 v[84:87], v[116:119], v[128:131], v[84:87]
  ds_read_b64 v[188:189], v60 offset:0
  v_mfma_f32_16x16x32_bf16 v[88:91], v[100:103], v[148:151], v[88:91]
  ds_read_b64 v[190:191], v61 offset:0
  v_mfma_f32_16x16x32_bf16 v[88:91], v[116:119], v[132:135], v[88:91]
  ds_read_b128 v[220:223], v62 offset:3584
  v_mfma_f32_16x16x32_bf16 v[92:95], v[104:107], v[148:151], v[92:95]
  v_mfma_f32_16x16x32_bf16 v[92:95], v[116:119], v[136:139], v[92:95]
  v_mfma_f32_16x16x32_bf16 v[88:91], v[96:99], v[152:155], v[88:91]
  v_mfma_f32_16x16x32_bf16 v[88:91], v[120:123], v[128:131], v[88:91]
  v_mfma_f32_16x16x32_bf16 v[92:95], v[100:103], v[152:155], v[92:95]
  v_mfma_f32_16x16x32_bf16 v[92:95], v[120:123], v[132:135], v[92:95]
  s_waitcnt lgkmcnt(15)
  v_mfma_f32_16x16x32_bf16 v[92:95], v[96:99], v[156:159], v[92:95]
  v_mfma_f32_16x16x32_bf16 v[92:95], v[124:127], v[128:131], v[92:95]
  v_subrev_u32 v60, 512, v60
  v_subrev_u32 v61, 512, v61
  v_subrev_u32 v62, 128, v62
  v_mfma_f32_16x16x32_bf16 v[64:67], v[160:163], v[192:195], v[64:67]
  v_mfma_f32_16x16x32_bf16 v[68:71], v[160:163], v[196:199], v[68:71]
  v_mfma_f32_16x16x32_bf16 v[68:71], v[164:167], v[192:195], v[68:71]
  v_mfma_f32_16x16x32_bf16 v[72:75], v[164:167], v[196:199], v[72:75]
  v_mfma_f32_16x16x32_bf16 v[72:75], v[160:163], v[200:203], v[72:75]
  ds_read_b64 v[96:97], v60 offset:14592
  v_mfma_f32_16x16x32_bf16 v[72:75], v[168:171], v[192:195], v[72:75]
  ds_read_b64 v[98:99], v61 offset:14592
  v_mfma_f32_16x16x32_bf16 v[76:79], v[164:167], v[200:203], v[76:79]
  ds_read_b128 v[128:131], v62 offset:64
  v_mfma_f32_16x16x32_bf16 v[76:79], v[168:171], v[196:199], v[76:79]
  ds_read_b64 v[100:101], v60 offset:12544
  v_mfma_f32_16x16x32_bf16 v[80:83], v[168:171], v[200:203], v[80:83]
  ds_read_b64 v[102:103], v61 offset:12544
  s_waitcnt lgkmcnt(15)
  v_mfma_f32_16x16x32_bf16 v[76:79], v[160:163], v[204:207], v[76:79]
  ds_read_b128 v[132:135], v62 offset:576
  v_mfma_f32_16x16x32_bf16 v[76:79], v[172:175], v[192:195], v[76:79]
  ds_read_b64 v[104:105], v60 offset:10496
  v_mfma_f32_16x16x32_bf16 v[80:83], v[164:167], v[204:207], v[80:83]
  ds_read_b64 v[106:107], v61 offset:10496
  v_mfma_f32_16x16x32_bf16 v[80:83], v[172:175], v[196:199], v[80:83]
  ds_read_b128 v[136:139], v62 offset:1088
  v_mfma_f32_16x16x32_bf16 v[84:87], v[168:171], v[204:207], v[84:87]
  ds_read_b64 v[108:109], v60 offset:8448
  v_mfma_f32_16x16x32_bf16 v[84:87], v[172:175], v[200:203], v[84:87]
  ds_read_b64 v[110:111], v61 offset:8448
  v_mfma_f32_16x16x32_bf16 v[88:91], v[172:175], v[204:207], v[88:91]
  ds_read_b128 v[140:143], v62 offset:1600
  s_waitcnt lgkmcnt(15)
  v_mfma_f32_16x16x32_bf16 v[80:83], v[160:163], v[208:211], v[80:83]
  ds_read_b64 v[112:113], v60 offset:6400
  v_mfma_f32_16x16x32_bf16 v[80:83], v[176:179], v[192:195], v[80:83]
  ds_read_b64 v[114:115], v61 offset:6400
  v_mfma_f32_16x16x32_bf16 v[84:87], v[164:167], v[208:211], v[84:87]
  ds_read_b128 v[144:147], v62 offset:2112
  v_mfma_f32_16x16x32_bf16 v[84:87], v[176:179], v[196:199], v[84:87]
  ds_read_b64 v[116:117], v60 offset:4352
  v_mfma_f32_16x16x32_bf16 v[88:91], v[168:171], v[208:211], v[88:91]
  ds_read_b64 v[118:119], v61 offset:4352
  v_mfma_f32_16x16x32_bf16 v[88:91], v[176:179], v[200:203], v[88:91]
  ds_read_b128 v[148:151], v62 offset:2624
  v_mfma_f32_16x16x32_bf16 v[92:95], v[172:175], v[208:211], v[92:95]
  ds_read_b64 v[120:121], v60 offset:2304
  v_mfma_f32_16x16x32_bf16 v[92:95], v[176:179], v[204:207], v[92:95]
  ds_read_b64 v[122:123], v61 offset:2304
  v_mfma_f32_16x16x32_bf16 v[84:87], v[160:163], v[212:215], v[84:87]
  ds_read_b128 v[152:155], v62 offset:3136
  v_mfma_f32_16x16x32_bf16 v[84:87], v[180:183], v[192:195], v[84:87]
  ds_read_b64 v[124:125], v60 offset:256
  v_mfma_f32_16x16x32_bf16 v[88:91], v[164:167], v[212:215], v[88:91]
  ds_read_b64 v[126:127], v61 offset:256
  v_mfma_f32_16x16x32_bf16 v[88:91], v[180:183], v[196:199], v[88:91]
  ds_read_b128 v[156:159], v62 offset:3648
  v_mfma_f32_16x16x32_bf16 v[92:95], v[168:171], v[212:215], v[92:95]
  v_mfma_f32_16x16x32_bf16 v[92:95], v[180:183], v[200:203], v[92:95]
  v_mfma_f32_16x16x32_bf16 v[88:91], v[160:163], v[216:219], v[88:91]
  v_mfma_f32_16x16x32_bf16 v[88:91], v[184:187], v[192:195], v[88:91]
  v_mfma_f32_16x16x32_bf16 v[92:95], v[164:167], v[216:219], v[92:95]
  v_mfma_f32_16x16x32_bf16 v[92:95], v[184:187], v[196:199], v[92:95]
  s_waitcnt lgkmcnt(15)
  v_mfma_f32_16x16x32_bf16 v[92:95], v[160:163], v[220:223], v[92:95]
  v_mfma_f32_16x16x32_bf16 v[92:95], v[188:191], v[192:195], v[92:95]
  v_mfma_f32_16x16x32_bf16 v[64:67], v[96:99], v[128:131], v[64:67]
  v_mfma_f32_16x16x32_bf16 v[68:71], v[96:99], v[132:135], v[68:71]
  v_mfma_f32_16x16x32_bf16 v[68:71], v[100:103], v[128:131], v[68:71]
  v_mfma_f32_16x16x32_bf16 v[72:75], v[100:103], v[132:135], v[72:75]
  v_mfma_f32_16x16x32_bf16 v[72:75], v[96:99], v[136:139], v[72:75]
  ds_read_b64 v[160:161], v60 offset:14336
  v_mfma_f32_16x16x32_bf16 v[72:75], v[104:107], v[128:131], v[72:75]
  ds_read_b64 v[162:163], v61 offset:14336
  v_mfma_f32_16x16x32_bf16 v[76:79], v[100:103], v[136:139], v[76:79]
  ds_read_b128 v[192:195], v62 offset:0
  v_mfma_f32_16x16x32_bf16 v[76:79], v[104:107], v[132:135], v[76:79]
  ds_read_b64 v[164:165], v60 offset:12288
  v_mfma_f32_16x16x32_bf16 v[80:83], v[104:107], v[136:139], v[80:83]
  ds_read_b64 v[166:167], v61 offset:12288
  s_waitcnt lgkmcnt(15)
  v_mfma_f32_16x16x32_bf16 v[76:79], v[96:99], v[140:143], v[76:79]
  ds_read_b128 v[196:199], v62 offset:512
  v_mfma_f32_16x16x32_bf16 v[76:79], v[108:111], v[128:131], v[76:79]
  ds_read_b64 v[168:169], v60 offset:10240
  v_mfma_f32_16x16x32_bf16 v[80:83], v[100:103], v[140:143], v[80:83]
  ds_read_b64 v[170:171], v61 offset:10240
  v_mfma_f32_16x16x32_bf16 v[80:83], v[108:111], v[132:135], v[80:83]
  ds_read_b128 v[200:203], v62 offset:1024
  v_mfma_f32_16x16x32_bf16 v[84:87], v[104:107], v[140:143], v[84:87]
  ds_read_b64 v[172:173], v60 offset:8192
  v_mfma_f32_16x16x32_bf16 v[84:87], v[108:111], v[136:139], v[84:87]
  ds_read_b64 v[174:175], v61 offset:8192
  v_mfma_f32_16x16x32_bf16 v[88:91], v[108:111], v[140:143], v[88:91]
  ds_read_b128 v[204:207], v62 offset:1536
  s_waitcnt lgkmcnt(15)
  v_mfma_f32_16x16x32_bf16 v[80:83], v[96:99], v[144:147], v[80:83]
  ds_read_b64 v[176:177], v60 offset:6144
  v_mfma_f32_16x16x32_bf16 v[80:83], v[112:115], v[128:131], v[80:83]
  ds_read_b64 v[178:179], v61 offset:6144
  v_mfma_f32_16x16x32_bf16 v[84:87], v[100:103], v[144:147], v[84:87]
  ds_read_b128 v[208:211], v62 offset:2048
  v_mfma_f32_16x16x32_bf16 v[84:87], v[112:115], v[132:135], v[84:87]
  ds_read_b64 v[180:181], v60 offset:4096
  v_mfma_f32_16x16x32_bf16 v[88:91], v[104:107], v[144:147], v[88:91]
  ds_read_b64 v[182:183], v61 offset:4096
  v_mfma_f32_16x16x32_bf16 v[88:91], v[112:115], v[136:139], v[88:91]
  ds_read_b128 v[212:215], v62 offset:2560
  v_mfma_f32_16x16x32_bf16 v[92:95], v[108:111], v[144:147], v[92:95]
  ds_read_b64 v[184:185], v60 offset:2048
  v_mfma_f32_16x16x32_bf16 v[92:95], v[112:115], v[140:143], v[92:95]
  ds_read_b64 v[186:187], v61 offset:2048
  v_mfma_f32_16x16x32_bf16 v[84:87], v[96:99], v[148:151], v[84:87]
  ds_read_b128 v[216:219], v62 offset:3072
  v_mfma_f32_16x16x32_bf16 v[84:87], v[116:119], v[128:131], v[84:87]
  ds_read_b64 v[188:189], v60 offset:0
  v_mfma_f32_16x16x32_bf16 v[88:91], v[100:103], v[148:151], v[88:91]
  ds_read_b64 v[190:191], v61 offset:0
  v_mfma_f32_16x16x32_bf16 v[88:91], v[116:119], v[132:135], v[88:91]
  ds_read_b128 v[220:223], v62 offset:3584
  v_mfma_f32_16x16x32_bf16 v[92:95], v[104:107], v[148:151], v[92:95]
  v_mfma_f32_16x16x32_bf16 v[92:95], v[116:119], v[136:139], v[92:95]
  v_mfma_f32_16x16x32_bf16 v[88:91], v[96:99], v[152:155], v[88:91]
  v_mfma_f32_16x16x32_bf16 v[88:91], v[120:123], v[128:131], v[88:91]
  v_mfma_f32_16x16x32_bf16 v[92:95], v[100:103], v[152:155], v[92:95]
  v_mfma_f32_16x16x32_bf16 v[92:95], v[120:123], v[132:135], v[92:95]
  s_waitcnt lgkmcnt(15)
  v_mfma_f32_16x16x32_bf16 v[92:95], v[96:99], v[156:159], v[92:95]
  v_mfma_f32_16x16x32_bf16 v[92:95], v[124:127], v[128:131], v[92:95]
  v_mfma_f32_16x16x32_bf16 v[64:67], v[160:163], v[192:195], v[64:67]
  v_mfma_f32_16x16x32_bf16 v[68:71], v[160:163], v[196:199], v[68:71]
  v_mfma_f32_16x16x32_bf16 v[68:71], v[164:167], v[192:195], v[68:71]
  v_mfma_f32_16x16x32_bf16 v[72:75], v[164:167], v[196:199], v[72:75]
  v_mfma_f32_16x16x32_bf16 v[72:75], v[160:163], v[200:203], v[72:75]
  v_mfma_f32_16x16x32_bf16 v[72:75], v[168:171], v[192:195], v[72:75]
  v_mfma_f32_16x16x32_bf16 v[76:79], v[164:167], v[200:203], v[76:79]
  v_mfma_f32_16x16x32_bf16 v[76:79], v[168:171], v[196:199], v[76:79]
  v_mfma_f32_16x16x32_bf16 v[80:83], v[168:171], v[200:203], v[80:83]
  s_waitcnt lgkmcnt(12)
  v_mfma_f32_16x16x32_bf16 v[76:79], v[160:163], v[204:207], v[76:79]
  v_mfma_f32_16x16x32_bf16 v[76:79], v[172:175], v[192:195], v[76:79]
  v_mfma_f32_16x16x32_bf16 v[80:83], v[164:167], v[204:207], v[80:83]
  v_mfma_f32_16x16x32_bf16 v[80:83], v[172:175], v[196:199], v[80:83]
  v_mfma_f32_16x16x32_bf16 v[84:87], v[168:171], v[204:207], v[84:87]
  v_mfma_f32_16x16x32_bf16 v[84:87], v[172:175], v[200:203], v[84:87]
  v_mfma_f32_16x16x32_bf16 v[88:91], v[172:175], v[204:207], v[88:91]
  s_waitcnt lgkmcnt(9)
  v_mfma_f32_16x16x32_bf16 v[80:83], v[160:163], v[208:211], v[80:83]
  v_mfma_f32_16x16x32_bf16 v[80:83], v[176:179], v[192:195], v[80:83]
  v_mfma_f32_16x16x32_bf16 v[84:87], v[164:167], v[208:211], v[84:87]
  v_mfma_f32_16x16x32_bf16 v[84:87], v[176:179], v[196:199], v[84:87]
  v_mfma_f32_16x16x32_bf16 v[88:91], v[168:171], v[208:211], v[88:91]
  v_mfma_f32_16x16x32_bf16 v[88:91], v[176:179], v[200:203], v[88:91]
  v_mfma_f32_16x16x32_bf16 v[92:95], v[172:175], v[208:211], v[92:95]
  v_mfma_f32_16x16x32_bf16 v[92:95], v[176:179], v[204:207], v[92:95]
  s_waitcnt lgkmcnt(6)
  v_mfma_f32_16x16x32_bf16 v[84:87], v[160:163], v[212:215], v[84:87]
  v_mfma_f32_16x16x32_bf16 v[84:87], v[180:183], v[192:195], v[84:87]
  v_mfma_f32_16x16x32_bf16 v[88:91], v[164:167], v[212:215], v[88:91]
  v_mfma_f32_16x16x32_bf16 v[88:91], v[180:183], v[196:199], v[88:91]
  v_mfma_f32_16x16x32_bf16 v[92:95], v[168:171], v[212:215], v[92:95]
  v_mfma_f32_16x16x32_bf16 v[92:95], v[180:183], v[200:203], v[92:95]
  s_waitcnt lgkmcnt(3)
  v_mfma_f32_16x16x32_bf16 v[88:91], v[160:163], v[216:219], v[88:91]
  v_mfma_f32_16x16x32_bf16 v[88:91], v[184:187], v[192:195], v[88:91]
  v_mfma_f32_16x16x32_bf16 v[92:95], v[164:167], v[216:219], v[92:95]
  v_mfma_f32_16x16x32_bf16 v[92:95], v[184:187], v[196:199], v[92:95]
  s_waitcnt lgkmcnt(0)
  v_mfma_f32_16x16x32_bf16 v[92:95], v[160:163], v[220:223], v[92:95]
  v_mfma_f32_16x16x32_bf16 v[92:95], v[188:191], v[192:195], v[92:95]
  v_lshl_add_u32 v5, v1, 4, s72
  s_xor_b32 s8, s3, 1
  s_mul_i32 s8, s8, 4608
  v_lshl_add_u32 v6, v1, 4, s8
  s_mul_i32 s8, s14, 4112
  s_lshl_b32 s9, s15, 11
  s_add_u32 s8, s8, s9
  s_add_u32 s8, s8, 103424
  v_lshl_add_u32 v7, v1, 3, s8
  s_lshl_b32 s9, s15, 13
  v_subrev_u32 v63, s9, v63
  ds_read_b64 v[144:145], v63 offset:14336
  ds_read_b64 v[146:147], v63 offset:12288
  ds_read_b64 v[148:149], v63 offset:10240
  ds_read_b64 v[150:151], v63 offset:8192
  s_cmp_lg_u32 s15, 0
  s_cbranch_scc1 Lc1_60
  ds_write_b128 v5, v[80:83] offset:0
  ds_write_b128 v5, v[84:87] offset:1024
  ds_write_b128 v5, v[88:91] offset:2048
  ds_write_b128 v5, v[92:95] offset:3072
  s_waitcnt lgkmcnt(4)
  v_and_b32 v176, 0xffff0000, v145
  v_lshlrev_b32 v177, 16, v145
  v_and_b32 v178, 0xffff0000, v144
  v_lshlrev_b32 v179, 16, v144
  v_fma_f32 v176, v176, s69, v64
  v_fma_f32 v177, v177, s69, v65
  v_fma_f32 v178, v178, s69, v66
  v_fma_f32 v179, v179, s69, v67
  v_and_b32 v180, 0xffff0000, v147
  v_lshlrev_b32 v181, 16, v147
  v_and_b32 v182, 0xffff0000, v146
  v_lshlrev_b32 v183, 16, v146
  v_fma_f32 v180, v180, s69, v68
  v_fma_f32 v181, v181, s69, v69
  v_fma_f32 v182, v182, s69, v70
  v_fma_f32 v183, v183, s69, v71
  v_and_b32 v184, 0xffff0000, v149
  v_lshlrev_b32 v185, 16, v149
  v_and_b32 v186, 0xffff0000, v148
  v_lshlrev_b32 v187, 16, v148
  v_fma_f32 v184, v184, s69, v72
  v_fma_f32 v185, v185, s69, v73
  v_fma_f32 v186, v186, s69, v74
  v_fma_f32 v187, v187, s69, v75
  v_and_b32 v188, 0xffff0000, v151
  v_lshlrev_b32 v189, 16, v151
  v_and_b32 v190, 0xffff0000, v150
  v_lshlrev_b32 v191, 16, v150
  v_fma_f32 v188, v188, s69, v76
  v_fma_f32 v189, v189, s69, v77
  v_fma_f32 v190, v190, s69, v78
  v_fma_f32 v191, v191, s69, v79
  s_branch Lcj_61
Lc1_60:
  ds_write_b128 v5, v[64:67] offset:0
  ds_write_b128 v5, v[68:71] offset:1024
  ds_write_b128 v5, v[72:75] offset:2048
  ds_write_b128 v5, v[76:79] offset:3072
  s_waitcnt lgkmcnt(4)
  v_and_b32 v176, 0xffff0000, v145
  v_lshlrev_b32 v177, 16, v145
  v_and_b32 v178, 0xffff0000, v144
  v_lshlrev_b32 v179, 16, v144
  v_fma_f32 v176, v176, s69, v80
  v_fma_f32 v177, v177, s69, v81
  v_fma_f32 v178, v178, s69, v82
  v_fma_f32 v179, v179, s69, v83
  v_and_b32 v180, 0xffff0000, v147
  v_lshlrev_b32 v181, 16, v147
  v_and_b32 v182, 0xffff0000, v146
  v_lshlrev_b32 v183, 16, v146
  v_fma_f32 v180, v180, s69, v84
  v_fma_f32 v181, v181, s69, v85
  v_fma_f32 v182, v182, s69, v86
  v_fma_f32 v183, v183, s69, v87
  v_and_b32 v184, 0xffff0000, v149
  v_lshlrev_b32 v185, 16, v149
  v_and_b32 v186, 0xffff0000, v148
  v_lshlrev_b32 v187, 16, v148
  v_fma_f32 v184, v184, s69, v88
  v_fma_f32 v185, v185, s69, v89
  v_fma_f32 v186, v186, s69, v90
  v_fma_f32 v187, v187, s69, v91
  v_and_b32 v188, 0xffff0000, v151
  v_lshlrev_b32 v189, 16, v151
  v_and_b32 v190, 0xffff0000, v150
  v_lshlrev_b32 v191, 16, v150
  v_fma_f32 v188, v188, s69, v92
  v_fma_f32 v189, v189, s69, v93
  v_fma_f32 v190, v190, s69, v94
  v_fma_f32 v191, v191, s69, v95
Lcj_61:
  s_waitcnt lgkmcnt(0)
  s_barrier
  ds_read_b128 v[96:99], v6 offset:0
  ds_read_b128 v[100:103], v6 offset:1024
  ds_read_b128 v[104:107], v6 offset:2048
  ds_read_b128 v[108:111], v6 offset:3072
  s_waitcnt lgkmcnt(3)
  v_pk_add_f32 v[176:177], v[176:177], v[96:97]
  v_pk_add_f32 v[178:179], v[178:179], v[98:99]
  v_cvt_pk_bf16_f32 v144, v176, v177
  v_cvt_pk_bf16_f32 v145, v178, v179
  ds_write_b64 v7, v[144:145] offset:0
  s_waitcnt lgkmcnt(3)
  v_pk_add_f32 v[180:181], v[180:181], v[100:101]
  v_pk_add_f32 v[182:183], v[182:183], v[102:103]
  v_cvt_pk_bf16_f32 v146, v180, v181
  v_cvt_pk_bf16_f32 v147, v182, v183
  ds_write_b64 v7, v[146:147] offset:512
  s_waitcnt lgkmcnt(3)
  v_pk_add_f32 v[184:185], v[184:185], v[104:105]
  v_pk_add_f32 v[186:187], v[186:187], v[106:107]
  v_cvt_pk_bf16_f32 v148, v184, v185
  v_cvt_pk_bf16_f32 v149, v186, v187
  ds_write_b64 v7, v[148:149] offset:1024
  s_waitcnt lgkmcnt(3)
  v_pk_add_f32 v[188:189], v[188:189], v[108:109]
  v_pk_add_f32 v[190:191], v[190:191], v[110:111]
  v_cvt_pk_bf16_f32 v150, v188, v189
  v_cvt_pk_bf16_f32 v151, v190, v191
  ds_write_b64 v7, v[150:151] offset:1536
  v_bfe_u32 v5, v1, 2, 2
  v_mul_u32_u24 v5, 4112, v5
  v_and_b32 v6, 3, v1
  v_lshl_add_u32 v5, v6, 7, v5
  v_lshl_add_u32 v5, v3, 3, v5
  s_lshl_b32 s8, s3, 9
  s_add_u32 s8, s8, 103424
  v_add_u32 v5, s8, v5
  v_mul_u32_u24 v6, 1792, v1
  s_mul_i32 s8, s3, 458752
  s_lshl_b32 s9, s5, 3
  s_add_u32 s8, s8, s9
  s_waitcnt lgkmcnt(0)
  s_barrier
  ds_read_b64_tr_b16 v[40:41], v5 offset:0
  ds_read_b64_tr_b16 v[42:43], v5 offset:32
  ds_read_b64_tr_b16 v[44:45], v5 offset:64
  ds_read_b64_tr_b16 v[46:47], v5 offset:96
  s_add_u32 s9, s8, 0
  s_waitcnt lgkmcnt(3)
  buffer_store_dwordx2 v[40:41], v6, s[64:67], s9 offen
  s_add_u32 s9, s8, 114688
  s_waitcnt lgkmcnt(2)
  buffer_store_dwordx2 v[42:43], v6, s[64:67], s9 offen
  s_add_u32 s9, s8, 229376
  s_waitcnt lgkmcnt(1)
  buffer_store_dwordx2 v[44:45], v6, s[64:67], s9 offen
  s_add_u32 s9, s8, 344064
  s_waitcnt lgkmcnt(0)
  buffer_store_dwordx2 v[46:47], v6, s[64:67], s9 offen
  s_branch L_end_concat_heads__ssm_conv_s4__linear_attn_block__prompt_kernel
L_end_concat_heads__ssm_conv_s4__linear_attn_block__prompt_kernel:
  s_endpgm
.section .rodata,"a"
.p2align 6
.amdhsa_kernel concat_heads__ssm_conv_s4__linear_attn_block__prompt_kernel
  .amdhsa_next_free_vgpr 248
  .amdhsa_next_free_sgpr 102
  .amdhsa_accum_offset 248
  .amdhsa_group_segment_fixed_size 0
  .amdhsa_kernarg_size 120
  .amdhsa_user_sgpr_count 2
  .amdhsa_user_sgpr_kernarg_segment_ptr 1
  .amdhsa_system_sgpr_workgroup_id_x 1
.end_amdhsa_kernel
```
